```python
import torch

def _softmax(x, axis=-1):
    return torch.softmax(x, dim=axis)
def _gelu(x):
    return torch.nn.functional.gelu(x, approximate="tanh")
def _silu(x):
    return torch.nn.functional.silu(x)
def _sigmoid(x):
    return torch.sigmoid(x)
def _layernorm(x, axis=-1, eps=1e-5):
    m = x.mean(dim=axis, keepdim=True)
    v = x.var(dim=axis, keepdim=True, unbiased=False)
    return (x - m) / torch.sqrt(v + eps)
def _scatter_add(tgt, idx, src, axis=0):
    return tgt.clone().index_add_(axis, idx, src)
def _segment_sum(src, seg, n):
    out = torch.zeros((n,) + src.shape[1:], dtype=src.dtype)
    return out.index_add_(0, seg, src)
def _pad(x, pw):
    flat = tuple(v for pair in reversed(pw) for v in pair)
    return torch.nn.functional.pad(x, flat)

kernel_name = 'recurrent_scan__sliding_block_cached__dense_activation_relu__decode'

def setup_inputs():

    _w = (lambda a: (lambda t: t.to(torch.bfloat16) if t.is_floating_point() else t)(torch.as_tensor(a)))
    def _A_setup():
        B, Sq, D = 1, 1, 512
        Hq, Hkv, Sk, Dh = 32, 8, 65536, 128
        assert Hq % Hkv == 0, (Hq, Hkv)
        return {
            "x": _w((lambda *s: torch.randn(*s, dtype=torch.bfloat16) * 0.05)(B, Sq, D)),
            "k_cache": _w((lambda *s: torch.randn(*s, dtype=torch.bfloat16) * 1.6)(B, Hkv, Sk, Dh)),
            "v_cache": _w((lambda *s: torch.randn(*s, dtype=torch.bfloat16) * 0.2)(B, Hkv, Sk, Dh)),
            "wq": _w((lambda *s: torch.randn(*s, dtype=torch.bfloat16) * 1.6)(D, Hq * Dh) * (D ** -0.5)),
            "wo": _w((lambda *s: torch.randn(*s, dtype=torch.bfloat16) * 0.2)(Hq * Dh, D) * ((Hq * Dh) ** -0.5)),
        }
    _A_in = _A_setup()

    def _B_setup():
        B, S, D, Dff = 1, 1, 512, 1792
        return {
            "x": _w((lambda *s: torch.randn(*s, dtype=torch.bfloat16) * 0.05)(B, S, D)),
            "w1": _w((lambda *s: torch.randn(*s, dtype=torch.bfloat16) * 0.1)(D, Dff)),
            "w2": _w((lambda *s: torch.randn(*s, dtype=torch.bfloat16) * 0.1)(Dff, D)),
        }
    _B_in = _B_setup()

    return {
        "A_x": _A_in["x"],
        "A_k_cache": _A_in["k_cache"],
        "A_v_cache": _A_in["v_cache"],
        "A_wq": _A_in["wq"],
        "A_wo": _A_in["wo"],
        "B_x": _B_in["x"],
        "B_w1": _B_in["w1"],
        "B_w2": _B_in["w2"],
    }

def reference(A_x, A_k_cache, A_v_cache, A_wq, A_wo, B_x, B_w1, B_w2):
    def _A_ref(x, k_cache, v_cache, wq, wo):
        B, Sq, D = x.shape
        Hq, Dh = 32, 128
        Hkv, Sk = k_cache.shape[1], k_cache.shape[2]
        W = min(4096, max(256, Sk // 4))
        rep = Hq // Hkv
        q = (lambda x, *d: x.permute(*d))((x @ wq).reshape(B, Sq, Hq, Dh), 0, 2, 1, 3)
        k = (lambda x, n, axis: torch.repeat_interleave(x, n, dim=axis))(k_cache[:, :, Sk - W:, :], rep, axis=1)
        v = (lambda x, n, axis: torch.repeat_interleave(x, n, dim=axis))(v_cache[:, :, Sk - W:, :], rep, axis=1)
        scores = torch.einsum("bhqd,bhkd->bhqk", q, k) * (Dh ** -0.5)
        p = _softmax(scores, axis=-1)
        o = torch.einsum("bhqk,bhkd->bhqd", p, v)
        return (lambda x, *d: x.permute(*d))(o, 0, 2, 1, 3).reshape(B, Sq, Hq * Dh) @ wo

    def _B_ref(x, w1, w2):
        h = torch.einsum("bsd,df->bsf", x, w1)
        zero = torch.zeros_like(h)
        h = torch.maximum(h, zero)
        return torch.einsum("bsf,fd->bsd", h, w2)

    x = A_x
    xn = _layernorm(x, axis=-1)
    s = _A_ref(xn, A_k_cache, A_v_cache, A_wq, A_wo)
    g = _silu(_B_ref(xn, B_w1, B_w2))
    return x + s * g
```

```asm
; @launch grid=(256,1,1) block=(512,1,1) lds=122880
.amdgcn_target "amdgcn-amd-amdhsa--gfx950"
.text
.globl recurrent_scan__sliding_block_cached__dense_activation_relu__decode_kernel
.p2align 8
.type recurrent_scan__sliding_block_cached__dense_activation_relu__decode_kernel,@function
recurrent_scan__sliding_block_cached__dense_activation_relu__decode_kernel:
    s_cmp_ge_u32 s2, 256
    s_cbranch_scc1 L_end
    s_load_dwordx16 s[4:19], s[0:1], 0
    s_load_dwordx4 s[20:23], s[0:1], 64
    s_load_dwordx2 s[24:25], s[0:1], 80
    v_lshrrev_b32 v1, 6, v0
    v_and_b32 v0, 63, v0
    s_and_b32 s26, s2, 7
    s_lshr_b32 s27, s2, 3
    v_readfirstlane_b32 s28, v1
    v_lshlrev_b32 v37, 4, v0
    s_lshr_b32 s40, s27, 3
    s_cmp_eq_u32 s28, 7
    s_cbranch_scc1 L_L
    s_cmp_eq_u32 s28, 5
    s_cbranch_scc1 L_C1
    s_cmp_eq_u32 s28, 6
    s_cbranch_scc1 L_C2
    s_cmp_lt_u32 s28, 4
    s_cbranch_scc1 L_A
    s_getpc_b64 s[52:53]
L_pc:
    s_lshl_b32 s54, s27, 10
    v_add_u32 v3, s54, v37
    v_min_u32 v3, L_code_end-L_pc-16, v3
    global_load_dwordx4 v[188:191], v3, s[52:53]
    s_lshl_b32 s41, s40, 8
    v_lshl_add_u32 v38, v0, 2, s41
    s_lshl_b32 s41, s40, 20
    s_lshl_b32 s42, s26, 10
    s_add_u32 s41, s41, s42
    s_and_b32 s42, s27, 7
    s_lshl_b32 s42, s42, 7
    s_add_u32 s41, s41, s42
    v_lshrrev_b32 v3, 3, v0
    v_lshlrev_b32 v3, 17, v3
    v_and_b32 v36, 7, v0
    v_lshl_add_u32 v3, v36, 4, v3
    v_add_u32 v3, s41, v3
    s_mov_b32 m0, 106496
    s_movk_i32 s41, 15
    s_waitcnt lgkmcnt(0)
    global_load_dwordx4 v[4:7], v37, s[4:5]
    global_load_dword v8, v38, s[4:5]
L_wq:
    global_load_lds_dwordx4 v3, s[10:11] nt
    v_add_u32 v3, 0x2000, v3
    s_addk_i32 m0, 0x400
    s_sub_u32 s41, s41, 1
    s_cbranch_scc0 L_wq
    s_barrier
L_C0_rest:
    s_setprio 3
    s_load_dwordx2 s[30:31], s[24:25], 0
    v_mov_b32 v1, 0
    v_mov_b32 v2, 1
    v_and_b32 v180, 15, v0
    v_and_b32 v181, 1, v180
    v_bfe_u32 v182, v180, 1, 2
    v_cmp_eq_u32 vcc, 1, v181
    v_mov_b32 v183, 0x0c0c0100
    v_mov_b32 v184, 0x01000c0c
    v_cndmask_b32 v185, v183, v184, vcc
    v_mov_b32 v183, 0x0c0c0302
    v_mov_b32 v184, 0x03020c0c
    v_cndmask_b32 v186, v183, v184, vcc
    v_mov_b32 v183, 0x0c0c0c0c
    v_cmp_eq_u32 vcc, 0, v182
    s_nop 1
    v_cndmask_b32 v168, v183, v185, vcc
    v_cndmask_b32 v172, v183, v186, vcc
    v_cmp_eq_u32 vcc, 1, v182
    s_nop 1
    v_cndmask_b32 v169, v183, v185, vcc
    v_cndmask_b32 v173, v183, v186, vcc
    v_cmp_eq_u32 vcc, 2, v182
    s_nop 1
    v_cndmask_b32 v170, v183, v185, vcc
    v_cndmask_b32 v174, v183, v186, vcc
    v_cmp_eq_u32 vcc, 3, v182
    s_nop 1
    v_cndmask_b32 v171, v183, v185, vcc
    v_cndmask_b32 v175, v183, v186, vcc
    s_waitcnt vmcnt(16)
    s_mov_b64 exec, 1
    ds_add_u32 v1, v2 offset:6812
    s_mov_b64 exec, -1
    v_lshlrev_b32 v20, 16, v4
    v_and_b32 v21, 0xffff0000, v4
    v_lshlrev_b32 v22, 16, v5
    v_and_b32 v23, 0xffff0000, v5
    v_lshlrev_b32 v24, 16, v6
    v_and_b32 v25, 0xffff0000, v6
    v_lshlrev_b32 v26, 16, v7
    v_and_b32 v27, 0xffff0000, v7
    v_add_f32 v28, v20, v21
    v_add_f32 v29, v22, v23
    v_add_f32 v30, v24, v25
    v_add_f32 v31, v26, v27
    v_add_f32 v28, v28, v29
    v_add_f32 v30, v30, v31
    v_add_f32 v28, v28, v30
    s_nop 1
    v_add_f32_dpp v28, v28, v28 quad_perm:[1,0,3,2] row_mask:0xf bank_mask:0xf
    s_nop 1
    v_add_f32_dpp v28, v28, v28 quad_perm:[2,3,0,1] row_mask:0xf bank_mask:0xf
    s_nop 1
    v_add_f32_dpp v28, v28, v28 row_half_mirror row_mask:0xf bank_mask:0xf
    s_nop 1
    v_add_f32_dpp v28, v28, v28 row_mirror row_mask:0xf bank_mask:0xf
    v_mov_b32 v32, v28
    s_nop 1
    v_permlane16_swap_b32 v28, v32
    v_add_f32 v28, v28, v32
    v_mov_b32 v32, v28
    s_nop 1
    v_permlane32_swap_b32 v28, v32
    v_add_f32 v28, v28, v32
    v_mul_f32 v28, 0x3b000000, v28
    v_sub_f32 v20, v20, v28
    v_sub_f32 v21, v21, v28
    v_sub_f32 v22, v22, v28
    v_sub_f32 v23, v23, v28
    v_sub_f32 v24, v24, v28
    v_sub_f32 v25, v25, v28
    v_sub_f32 v26, v26, v28
    v_sub_f32 v27, v27, v28
    v_mul_f32 v29, v20, v20
    v_mul_f32 v30, v21, v21
    v_fmac_f32 v29, v22, v22
    v_fmac_f32 v30, v23, v23
    v_fmac_f32 v29, v24, v24
    v_fmac_f32 v30, v25, v25
    v_fmac_f32 v29, v26, v26
    v_fmac_f32 v30, v27, v27
    v_add_f32 v29, v29, v30
    s_nop 1
    v_add_f32_dpp v29, v29, v29 quad_perm:[1,0,3,2] row_mask:0xf bank_mask:0xf
    s_nop 1
    v_add_f32_dpp v29, v29, v29 quad_perm:[2,3,0,1] row_mask:0xf bank_mask:0xf
    s_nop 1
    v_add_f32_dpp v29, v29, v29 row_half_mirror row_mask:0xf bank_mask:0xf
    s_nop 1
    v_add_f32_dpp v29, v29, v29 row_mirror row_mask:0xf bank_mask:0xf
    v_mov_b32 v32, v29
    s_nop 1
    v_permlane16_swap_b32 v29, v32
    v_add_f32 v29, v29, v32
    v_mov_b32 v32, v29
    s_nop 1
    v_permlane32_swap_b32 v29, v32
    v_add_f32 v29, v29, v32
    v_mul_f32 v29, 0x3b000000, v29
    v_cvt_pk_bf16_f32 v30, v28, v29
    v_lshlrev_b32 v28, 16, v30
    v_and_b32 v29, 0xffff0000, v30
    v_add_f32 v29, 0x3727c5ac, v29
    v_cvt_pk_bf16_f32 v29, v29, v29
    v_and_b32 v29, 0xffff0000, v29
    v_sqrt_f32 v29, v29
    s_nop 0
    v_cvt_pk_bf16_f32 v29, v29, v29
    v_and_b32 v29, 0xffff0000, v29
    v_rcp_f32 v30, v29
    v_lshlrev_b32 v20, 16, v8
    v_and_b32 v21, 0xffff0000, v8
    v_sub_f32 v20, v20, v28
    v_sub_f32 v21, v21, v28
    v_cvt_pk_bf16_f32 v20, v20, v21
    v_and_b32 v21, 0xffff0000, v20
    v_lshlrev_b32 v20, 16, v20
    v_mul_f32 v22, v20, v30
    v_mul_f32 v23, v21, v30
    v_fma_f32 v24, -v22, v29, v20
    v_fma_f32 v25, -v23, v29, v21
    v_fmac_f32 v22, v24, v30
    v_fmac_f32 v23, v25, v30
    v_cvt_pk_bf16_f32 v20, v22, v23
    v_lshlrev_b32 v28, 2, v0
    ds_write_b32 v28, v20 offset:6272
    v_lshrrev_b32 v28, 3, v0
    v_lshlrev_b32 v28, 5, v28
    ds_read_b128 v[12:15], v28 offset:6272
    ds_read_b128 v[16:19], v28 offset:6288
    s_getreg_b32 s32, hwreg(HW_REG_XCC_ID, 0, 4)
    s_waitcnt lgkmcnt(0)
    s_add_u32 s30, s30, 0x9E3779B9
    s_add_u32 s31, s31, 0x7F4A7C00
    s_and_b32 s31, s31, 0xFFFFFFE0
    s_or_b32 s31, s31, 0x10
    s_mov_b32 s36, s30
    s_or_b32 s37, s31, s32
    s_and_b32 s52, s30, 0x3ff
    s_bfe_u32 s53, s30, 0xA000A
    s_bfe_u32 s54, s30, 0xA0014
    s_bfe_u32 s55, s31, 0xA0008
    s_movk_i32 s56, 0x3ff
    s_mov_b32 s57, 0xfffffc00
    s_waitcnt lgkmcnt(0)
    v_add_u32 v37, 106496, v37
    v_perm_b32 v104, v12, v12, v168
    v_perm_b32 v105, v12, v12, v169
    v_perm_b32 v106, v12, v12, v170
    v_perm_b32 v107, v12, v12, v171
    v_perm_b32 v108, v12, v12, v172
    v_perm_b32 v109, v12, v12, v173
    v_perm_b32 v110, v12, v12, v174
    v_perm_b32 v111, v12, v12, v175
    v_perm_b32 v112, v13, v13, v168
    v_perm_b32 v113, v13, v13, v169
    v_perm_b32 v114, v13, v13, v170
    v_perm_b32 v115, v13, v13, v171
    v_perm_b32 v116, v13, v13, v172
    v_perm_b32 v117, v13, v13, v173
    v_perm_b32 v118, v13, v13, v174
    v_perm_b32 v119, v13, v13, v175
    v_perm_b32 v120, v14, v14, v168
    v_perm_b32 v121, v14, v14, v169
    v_perm_b32 v122, v14, v14, v170
    v_perm_b32 v123, v14, v14, v171
    v_perm_b32 v124, v14, v14, v172
    v_perm_b32 v125, v14, v14, v173
    v_perm_b32 v126, v14, v14, v174
    v_perm_b32 v127, v14, v14, v175
    v_perm_b32 v128, v15, v15, v168
    v_perm_b32 v129, v15, v15, v169
    v_perm_b32 v130, v15, v15, v170
    v_perm_b32 v131, v15, v15, v171
    v_perm_b32 v132, v15, v15, v172
    v_perm_b32 v133, v15, v15, v173
    v_perm_b32 v134, v15, v15, v174
    v_perm_b32 v135, v15, v15, v175
    v_perm_b32 v136, v16, v16, v168
    v_perm_b32 v137, v16, v16, v169
    v_perm_b32 v138, v16, v16, v170
    v_perm_b32 v139, v16, v16, v171
    v_perm_b32 v140, v16, v16, v172
    v_perm_b32 v141, v16, v16, v173
    v_perm_b32 v142, v16, v16, v174
    v_perm_b32 v143, v16, v16, v175
    v_perm_b32 v144, v17, v17, v168
    v_perm_b32 v145, v17, v17, v169
    v_perm_b32 v146, v17, v17, v170
    v_perm_b32 v147, v17, v17, v171
    v_perm_b32 v148, v17, v17, v172
    v_perm_b32 v149, v17, v17, v173
    v_perm_b32 v150, v17, v17, v174
    v_perm_b32 v151, v17, v17, v175
    v_perm_b32 v152, v18, v18, v168
    v_perm_b32 v153, v18, v18, v169
    v_perm_b32 v154, v18, v18, v170
    v_perm_b32 v155, v18, v18, v171
    v_perm_b32 v156, v18, v18, v172
    v_perm_b32 v157, v18, v18, v173
    v_perm_b32 v158, v18, v18, v174
    v_perm_b32 v159, v18, v18, v175
    v_perm_b32 v160, v19, v19, v168
    v_perm_b32 v161, v19, v19, v169
    v_perm_b32 v162, v19, v19, v170
    v_perm_b32 v163, v19, v19, v171
    v_perm_b32 v164, v19, v19, v172
    v_perm_b32 v165, v19, v19, v173
    v_perm_b32 v166, v19, v19, v174
    v_perm_b32 v167, v19, v19, v175
    s_waitcnt vmcnt(12)
    ds_read_b128 v[40:43], v37 offset:0
    ds_read_b128 v[44:47], v37 offset:1024
    ds_read_b128 v[48:51], v37 offset:2048
    ds_read_b128 v[52:55], v37 offset:3072
    s_waitcnt vmcnt(8)
    ds_read_b128 v[56:59], v37 offset:4096
    ds_read_b128 v[60:63], v37 offset:5120
    ds_read_b128 v[64:67], v37 offset:6144
    ds_read_b128 v[68:71], v37 offset:7168
    s_waitcnt lgkmcnt(7)
    v_mfma_f32_16x16x32_bf16 v[176:179], v[104:107], v[40:43], 0
    s_waitcnt lgkmcnt(6)
    v_mfma_f32_16x16x32_bf16 v[176:179], v[108:111], v[44:47], v[176:179]
    s_waitcnt lgkmcnt(5)
    v_mfma_f32_16x16x32_bf16 v[176:179], v[112:115], v[48:51], v[176:179]
    s_waitcnt lgkmcnt(4)
    v_mfma_f32_16x16x32_bf16 v[176:179], v[116:119], v[52:55], v[176:179]
    s_waitcnt vmcnt(4)
    ds_read_b128 v[72:75], v37 offset:8192
    ds_read_b128 v[76:79], v37 offset:9216
    ds_read_b128 v[80:83], v37 offset:10240
    ds_read_b128 v[84:87], v37 offset:11264
    s_waitcnt lgkmcnt(7)
    v_mfma_f32_16x16x32_bf16 v[176:179], v[120:123], v[56:59], v[176:179]
    s_waitcnt lgkmcnt(6)
    v_mfma_f32_16x16x32_bf16 v[176:179], v[124:127], v[60:63], v[176:179]
    s_waitcnt lgkmcnt(5)
    v_mfma_f32_16x16x32_bf16 v[176:179], v[128:131], v[64:67], v[176:179]
    s_waitcnt lgkmcnt(4)
    v_mfma_f32_16x16x32_bf16 v[176:179], v[132:135], v[68:71], v[176:179]
    s_waitcnt vmcnt(0)
    ds_read_b128 v[88:91], v37 offset:12288
    ds_read_b128 v[92:95], v37 offset:13312
    ds_read_b128 v[96:99], v37 offset:14336
    ds_read_b128 v[100:103], v37 offset:15360
    s_waitcnt lgkmcnt(7)
    v_mfma_f32_16x16x32_bf16 v[176:179], v[136:139], v[72:75], v[176:179]
    s_waitcnt lgkmcnt(6)
    v_mfma_f32_16x16x32_bf16 v[176:179], v[140:143], v[76:79], v[176:179]
    s_waitcnt lgkmcnt(5)
    v_mfma_f32_16x16x32_bf16 v[176:179], v[144:147], v[80:83], v[176:179]
    s_waitcnt lgkmcnt(4)
    v_mfma_f32_16x16x32_bf16 v[176:179], v[148:151], v[84:87], v[176:179]
    s_waitcnt lgkmcnt(3)
    v_mfma_f32_16x16x32_bf16 v[176:179], v[152:155], v[88:91], v[176:179]
    s_waitcnt lgkmcnt(2)
    v_mfma_f32_16x16x32_bf16 v[176:179], v[156:159], v[92:95], v[176:179]
    s_waitcnt lgkmcnt(1)
    v_mfma_f32_16x16x32_bf16 v[176:179], v[160:163], v[96:99], v[176:179]
    s_waitcnt lgkmcnt(0)
    v_mfma_f32_16x16x32_bf16 v[176:179], v[164:167], v[100:103], v[176:179]
    s_nop 7
    v_permlane32_swap_b32 v176, v178
    v_permlane32_swap_b32 v177, v179
    s_nop 1
    v_add_f32_dpp v176, v178, v176 row_ror:8 row_mask:0xf bank_mask:0xf
    v_add_f32_dpp v177, v179, v177 row_ror:8 row_mask:0xf bank_mask:0xf
    v_mov_b32 v178, s36
    v_mov_b32 v179, s37
    s_lshl_b32 s41, s26, 14
    s_lshr_b32 s42, s27, 3
    s_lshl_b32 s42, s42, 12
    s_add_u32 s41, s41, s42
    s_and_b32 s42, s27, 7
    s_lshl_b32 s42, s42, 9
    s_add_u32 s41, s41, s42
    s_add_u32 s41, s41, 65536
    v_lshrrev_b32 v3, 4, v0
    v_lshlrev_b32 v3, 3, v3
    v_and_b32 v36, 7, v0
    v_add_u32 v3, v3, v36
    v_lshl_add_u32 v3, v3, 4, s41
    v_add_u32 v37, 4194304, v3
    s_mov_b32 s42, 0x00ff00ff
    s_mov_b32 s43, 0x00ff00ff
    s_mov_b64 exec, s[42:43]
    global_store_dwordx4 v3, v[176:179], s[24:25]
    s_mov_b64 exec, -1
    s_waitcnt vmcnt(0)
    s_mov_b64 exec, 1
    ds_add_u32 v1, v2 offset:6816
    s_mov_b64 exec, -1
    s_lshl_b32 s41, s26, 11
    s_lshr_b32 s42, s27, 3
    s_lshl_b32 s42, s42, 9
    s_add_u32 s41, s41, s42
    s_add_u32 s41, s41, 327680
    v_lshrrev_b32 v3, 3, v0
    v_lshl_add_u32 v4, v3, 4, s41
    s_lshl_b32 s41, s26, 16
    s_lshr_b32 s42, s27, 1
    s_lshl_b32 s42, s42, 12
    s_add_u32 s41, s41, s42
    s_add_u32 s41, s41, 1048576
    v_lshl_add_u32 v5, v0, 4, s41
    v_lshlrev_b32 v6, 4, v0
    s_mov_b32 s39, 0
W_1:
    ds_read_b32 v180, v1 offset:6792
    s_waitcnt lgkmcnt(0)
    v_readfirstlane_b32 s40, v180
    s_cmp_ge_u32 s40, 1
    s_cbranch_scc1 W_2
    s_sleep 2
    s_add_u32 s39, s39, 1
    s_cmp_lt_u32 s39, 1048576
    s_cbranch_scc1 W_1
    s_branch L_end
W_2:
    ds_read_b32 v180, v1 offset:6796
    s_waitcnt lgkmcnt(0)
    v_readfirstlane_b32 s33, v180
    s_min_u32 s33, s33, 1
    s_mul_i32 s40, s33, 4194304
    s_add_u32 s34, s24, s40
    s_addc_u32 s35, s25, 0
    s_mov_b32 s39, 0
W_3:
    ds_read_b32 v180, v1 offset:6820
    s_waitcnt lgkmcnt(0)
    v_readfirstlane_b32 s40, v180
    s_cmp_ge_u32 s40, 4
    s_cbranch_scc1 W_4
    s_sleep 1
    s_add_u32 s39, s39, 1
    s_cmp_lt_u32 s39, 1048576
    s_cbranch_scc1 W_3
    s_branch L_end
W_4:
    s_mov_b32 s39, 0
P_5:
    global_load_dwordx4 v[8:11], v4, s[34:35] offset:0 sc1
    global_load_dwordx4 v[12:15], v4, s[34:35] offset:128 sc1
    global_load_dwordx4 v[16:19], v4, s[34:35] offset:256 sc1
    global_load_dwordx4 v[20:23], v4, s[34:35] offset:384 sc1
    global_load_dwordx4 v[40:43], v5, s[34:35] offset:0 sc1
    global_load_dwordx4 v[44:47], v5, s[34:35] offset:1024 sc1
    global_load_dwordx4 v[48:51], v5, s[34:35] offset:2048 sc1
    global_load_dwordx4 v[52:55], v5, s[34:35] offset:3072 sc1
    s_waitcnt vmcnt(7)
    v_cmp_ne_u64 s[46:47], v[10:11], s[30:31]
    s_waitcnt vmcnt(6)
    v_cmp_ne_u64 s[40:41], v[14:15], s[30:31]
    s_or_b64 s[46:47], s[46:47], s[40:41]
    s_waitcnt vmcnt(5)
    v_cmp_ne_u64 s[40:41], v[18:19], s[30:31]
    s_or_b64 s[46:47], s[46:47], s[40:41]
    s_waitcnt vmcnt(4)
    v_cmp_ne_u64 s[40:41], v[22:23], s[30:31]
    s_or_b64 s[46:47], s[46:47], s[40:41]
    s_waitcnt vmcnt(3)
    v_xor_b32 v181, s52, v40
    v_xor_b32 v182, s53, v41
    v_xor_b32 v183, s54, v42
    v_xor_b32 v184, s55, v43
    v_or3_b32 v180, v181, v182, v183
    v_or_b32 v180, v180, v184
    s_waitcnt vmcnt(2)
    v_xor_b32 v181, s52, v44
    v_xor_b32 v182, s53, v45
    v_xor_b32 v183, s54, v46
    v_xor_b32 v184, s55, v47
    v_or3_b32 v180, v180, v181, v182
    v_or3_b32 v180, v180, v183, v184
    s_waitcnt vmcnt(1)
    v_xor_b32 v181, s52, v48
    v_xor_b32 v182, s53, v49
    v_xor_b32 v183, s54, v50
    v_xor_b32 v184, s55, v51
    v_or3_b32 v180, v180, v181, v182
    v_or3_b32 v180, v180, v183, v184
    s_waitcnt vmcnt(0)
    v_xor_b32 v181, s52, v52
    v_xor_b32 v182, s53, v53
    v_xor_b32 v183, s54, v54
    v_xor_b32 v184, s55, v55
    v_or3_b32 v180, v180, v181, v182
    v_or3_b32 v180, v180, v183, v184
    v_and_b32 v180, s56, v180
    v_cmp_ne_u32 vcc, 0, v180
    s_or_b64 vcc, vcc, s[46:47]
    s_cbranch_vccz P_6
    s_add_u32 s39, s39, 1
    s_cmp_le_u32 s39, 65536
    s_cbranch_scc1 P_5
    s_branch L_end
P_6:
    v_max3_f32 v24, v8, v12, v16
    v_max_f32 v24, v24, v20
    v_and_b32 v40, s57, v40
    v_and_b32 v41, s57, v41
    v_and_b32 v42, s57, v42
    v_and_b32 v43, s57, v43
    s_nop 1
    v_max_f32_dpp v24, v24, v24 row_ror:8 row_mask:0xf bank_mask:0xf
    v_mov_b32 v180, v24
    s_nop 1
    v_permlane16_swap_b32 v24, v180
    v_max_f32 v24, v24, v180
    v_mov_b32 v180, v24
    s_nop 1
    v_permlane32_swap_b32 v24, v180
    v_max_f32 v24, v24, v180
    v_mov_b32 v184, 0x3fb8aa3b
    v_mul_f32 v185, v24, v184
    v_fma_f32 v56, v8, v184, -v185
    v_fma_f32 v57, v12, v184, -v185
    v_fma_f32 v58, v16, v184, -v185
    v_fma_f32 v59, v20, v184, -v185
    v_exp_f32 v56, v56
    v_exp_f32 v57, v57
    v_exp_f32 v58, v58
    v_exp_f32 v59, v59
    v_and_b32 v44, s57, v44
    v_and_b32 v45, s57, v45
    v_and_b32 v46, s57, v46
    v_and_b32 v47, s57, v47
    v_and_b32 v48, s57, v48
    v_and_b32 v49, s57, v49
    v_and_b32 v50, s57, v50
    v_and_b32 v51, s57, v51
    v_and_b32 v52, s57, v52
    v_and_b32 v53, s57, v53
    v_and_b32 v54, s57, v54
    v_and_b32 v55, s57, v55
    v_mul_f32 v25, v56, v9
    v_mul_f32 v28, v56, v40
    v_mul_f32 v29, v56, v41
    v_mul_f32 v30, v56, v42
    v_mul_f32 v31, v56, v43
    v_fmac_f32 v25, v57, v13
    v_fmac_f32 v28, v57, v44
    v_fmac_f32 v29, v57, v45
    v_fmac_f32 v30, v57, v46
    v_fmac_f32 v31, v57, v47
    v_fmac_f32 v25, v58, v17
    v_fmac_f32 v28, v58, v48
    v_fmac_f32 v29, v58, v49
    v_fmac_f32 v30, v58, v50
    v_fmac_f32 v31, v58, v51
    v_fmac_f32 v25, v59, v21
    v_fmac_f32 v28, v59, v52
    v_fmac_f32 v29, v59, v53
    v_fmac_f32 v30, v59, v54
    v_fmac_f32 v31, v59, v55
    s_nop 1
    v_add_f32_dpp v25, v25, v25 row_ror:8 row_mask:0xf bank_mask:0xf
    v_add_f32_dpp v28, v28, v28 row_ror:8 row_mask:0xf bank_mask:0xf
    v_add_f32_dpp v29, v29, v29 row_ror:8 row_mask:0xf bank_mask:0xf
    v_add_f32_dpp v30, v30, v30 row_ror:8 row_mask:0xf bank_mask:0xf
    v_add_f32_dpp v31, v31, v31 row_ror:8 row_mask:0xf bank_mask:0xf
    v_mov_b32 v180, v25
    v_mov_b32 v181, v28
    v_mov_b32 v182, v29
    v_mov_b32 v183, v30
    v_mov_b32 v184, v31
    v_permlane16_swap_b32 v25, v180
    v_permlane16_swap_b32 v28, v181
    v_permlane16_swap_b32 v29, v182
    v_permlane16_swap_b32 v30, v183
    v_permlane16_swap_b32 v31, v184
    v_add_f32 v25, v25, v180
    v_add_f32 v28, v28, v181
    v_add_f32 v29, v29, v182
    v_add_f32 v30, v30, v183
    v_add_f32 v31, v31, v184
    v_mov_b32 v180, v25
    v_mov_b32 v181, v28
    v_mov_b32 v182, v29
    v_mov_b32 v183, v30
    v_mov_b32 v184, v31
    v_permlane32_swap_b32 v25, v180
    v_permlane32_swap_b32 v28, v181
    v_permlane32_swap_b32 v29, v182
    v_permlane32_swap_b32 v30, v183
    v_permlane32_swap_b32 v31, v184
    v_add_f32 v25, v25, v180
    v_add_f32 v28, v28, v181
    v_add_f32 v29, v29, v182
    v_add_f32 v30, v30, v183
    v_add_f32 v31, v31, v184
    v_rcp_f32 v180, v25
    v_mov_b32 v33, 1
    v_mov_b32 v35, 1
    v_fma_f32 v181, -v180, v25, 1.0
    v_fmac_f32 v180, v181, v180
    v_mul_f32 v28, v28, v180
    v_mul_f32 v29, v29, v180
    v_mul_f32 v30, v30, v180
    v_mul_f32 v31, v31, v180
    v_cvt_pk_bf16_f32 v32, v28, v29
    v_cvt_pk_bf16_f32 v34, v30, v31
    s_mov_b64 exec, 0xff
    ds_write_b128 v6, v[32:35] offset:6848
    s_mov_b64 exec, -1
    s_endpgm
L_C1:
    v_mov_b32 v1, 0
    v_mov_b32 v2, 1
    s_barrier
    s_setprio 3
    s_cmp_lt_u32 s26, 4
    s_cselect_b32 s49, 32, 24
    s_cmp_lt_u32 s27, s49
    s_cselect_b32 s38, 1, 0
    s_mul_i32 s50, s26, 4
    s_sub_u32 s51, s26, 4
    s_mul_i32 s51, s51, 3
    s_add_u32 s51, s51, 16
    s_cmp_lt_u32 s26, 4
    s_cselect_b32 s50, s50, s51
    s_lshr_b32 s51, s27, 3
    s_add_u32 s50, s50, s51
    v_lshlrev_b32 v42, 4, v0
    s_and_b32 s40, s27, 7
    s_lshl_b32 s41, s40, 7
    v_and_b32 v3, 31, v0
    v_lshl_add_u32 v43, v3, 2, s41
    s_lshl_b32 s42, s50, 7
    s_and_b32 s43, s27, 7
    s_mul_i32 s43, s43, 229376
    s_add_u32 s42, s42, s43
    v_lshrrev_b32 v6, 3, v0
    v_mul_u32_u24 v6, 28672, v6
    v_and_b32 v7, 7, v0
    v_lshl_add_u32 v6, v7, 4, v6
    v_add_u32 v44, s42, v6
    s_waitcnt lgkmcnt(0)
    s_load_dwordx2 s[30:31], s[24:25], 0
    s_lshl_b32 s41, s26, 14
    s_lshl_b32 s42, s27, 9
    s_add_u32 s44, s41, s42
    s_add_u32 s44, s44, 524288
    s_cmp_lg_u32 s38, 0
    s_cbranch_scc1 B_7
    s_endpgm
B_7:
    global_load_dwordx4 v[4:7], v42, s[4:5]
    global_load_dword v8, v43, s[4:5]
    global_load_dwordx4 v[48:51], v44, s[16:17] nt
    v_add_u32 v44, 3584, v44
    global_load_dwordx4 v[52:55], v44, s[16:17] nt
    v_add_u32 v44, 3584, v44
    global_load_dwordx4 v[56:59], v44, s[16:17] nt
    v_add_u32 v44, 3584, v44
    global_load_dwordx4 v[60:63], v44, s[16:17] nt
    v_add_u32 v44, 3584, v44
    global_load_dwordx4 v[64:67], v44, s[16:17] nt
    v_add_u32 v44, 3584, v44
    global_load_dwordx4 v[68:71], v44, s[16:17] nt
    v_add_u32 v44, 3584, v44
    global_load_dwordx4 v[72:75], v44, s[16:17] nt
    v_add_u32 v44, 3584, v44
    global_load_dwordx4 v[76:79], v44, s[16:17] nt
    s_waitcnt vmcnt(8)
    v_and_b32 v180, 15, v0
    v_and_b32 v181, 1, v180
    v_bfe_u32 v182, v180, 1, 2
    v_cmp_eq_u32 vcc, 1, v181
    v_mov_b32 v183, 0x0c0c0100
    v_mov_b32 v184, 0x01000c0c
    v_cndmask_b32 v185, v183, v184, vcc
    v_mov_b32 v183, 0x0c0c0302
    v_mov_b32 v184, 0x03020c0c
    v_cndmask_b32 v186, v183, v184, vcc
    v_mov_b32 v183, 0x0c0c0c0c
    v_cmp_eq_u32 vcc, 0, v182
    s_nop 1
    v_cndmask_b32 v168, v183, v185, vcc
    v_cndmask_b32 v172, v183, v186, vcc
    v_cmp_eq_u32 vcc, 1, v182
    s_nop 1
    v_cndmask_b32 v169, v183, v185, vcc
    v_cndmask_b32 v173, v183, v186, vcc
    v_cmp_eq_u32 vcc, 2, v182
    s_nop 1
    v_cndmask_b32 v170, v183, v185, vcc
    v_cndmask_b32 v174, v183, v186, vcc
    v_cmp_eq_u32 vcc, 3, v182
    s_nop 1
    v_cndmask_b32 v171, v183, v185, vcc
    v_cndmask_b32 v175, v183, v186, vcc
    v_lshlrev_b32 v20, 16, v4
    v_and_b32 v21, 0xffff0000, v4
    v_lshlrev_b32 v22, 16, v5
    v_and_b32 v23, 0xffff0000, v5
    v_lshlrev_b32 v24, 16, v6
    v_and_b32 v25, 0xffff0000, v6
    v_lshlrev_b32 v26, 16, v7
    v_and_b32 v27, 0xffff0000, v7
    v_add_f32 v28, v20, v21
    v_add_f32 v29, v22, v23
    v_add_f32 v30, v24, v25
    v_add_f32 v31, v26, v27
    v_add_f32 v28, v28, v29
    v_add_f32 v30, v30, v31
    v_add_f32 v28, v28, v30
    s_nop 1
    v_add_f32_dpp v28, v28, v28 quad_perm:[1,0,3,2] row_mask:0xf bank_mask:0xf
    s_nop 1
    v_add_f32_dpp v28, v28, v28 quad_perm:[2,3,0,1] row_mask:0xf bank_mask:0xf
    s_nop 1
    v_add_f32_dpp v28, v28, v28 row_half_mirror row_mask:0xf bank_mask:0xf
    s_nop 1
    v_add_f32_dpp v28, v28, v28 row_mirror row_mask:0xf bank_mask:0xf
    v_mov_b32 v32, v28
    s_nop 1
    v_permlane16_swap_b32 v28, v32
    v_add_f32 v28, v28, v32
    v_mov_b32 v32, v28
    s_nop 1
    v_permlane32_swap_b32 v28, v32
    v_add_f32 v28, v28, v32
    v_mul_f32 v28, 0x3b000000, v28
    v_sub_f32 v20, v20, v28
    v_sub_f32 v21, v21, v28
    v_sub_f32 v22, v22, v28
    v_sub_f32 v23, v23, v28
    v_sub_f32 v24, v24, v28
    v_sub_f32 v25, v25, v28
    v_sub_f32 v26, v26, v28
    v_sub_f32 v27, v27, v28
    v_mul_f32 v29, v20, v20
    v_mul_f32 v30, v21, v21
    v_fmac_f32 v29, v22, v22
    v_fmac_f32 v30, v23, v23
    v_fmac_f32 v29, v24, v24
    v_fmac_f32 v30, v25, v25
    v_fmac_f32 v29, v26, v26
    v_fmac_f32 v30, v27, v27
    v_add_f32 v29, v29, v30
    s_nop 1
    v_add_f32_dpp v29, v29, v29 quad_perm:[1,0,3,2] row_mask:0xf bank_mask:0xf
    s_nop 1
    v_add_f32_dpp v29, v29, v29 quad_perm:[2,3,0,1] row_mask:0xf bank_mask:0xf
    s_nop 1
    v_add_f32_dpp v29, v29, v29 row_half_mirror row_mask:0xf bank_mask:0xf
    s_nop 1
    v_add_f32_dpp v29, v29, v29 row_mirror row_mask:0xf bank_mask:0xf
    v_mov_b32 v32, v29
    s_nop 1
    v_permlane16_swap_b32 v29, v32
    v_add_f32 v29, v29, v32
    v_mov_b32 v32, v29
    s_nop 1
    v_permlane32_swap_b32 v29, v32
    v_add_f32 v29, v29, v32
    v_mul_f32 v29, 0x3b000000, v29
    v_cvt_pk_bf16_f32 v30, v28, v29
    v_lshlrev_b32 v28, 16, v30
    v_and_b32 v29, 0xffff0000, v30
    v_add_f32 v29, 0x3727c5ac, v29
    v_cvt_pk_bf16_f32 v29, v29, v29
    v_and_b32 v29, 0xffff0000, v29
    v_sqrt_f32 v29, v29
    s_nop 0
    v_cvt_pk_bf16_f32 v29, v29, v29
    v_and_b32 v29, 0xffff0000, v29
    v_rcp_f32 v30, v29
    v_lshlrev_b32 v20, 16, v8
    v_and_b32 v21, 0xffff0000, v8
    v_sub_f32 v20, v20, v28
    v_sub_f32 v21, v21, v28
    v_cvt_pk_bf16_f32 v20, v20, v21
    v_and_b32 v21, 0xffff0000, v20
    v_lshlrev_b32 v20, 16, v20
    v_mul_f32 v22, v20, v30
    v_mul_f32 v23, v21, v30
    v_fma_f32 v24, -v22, v29, v20
    v_fma_f32 v25, -v23, v29, v21
    v_fmac_f32 v22, v24, v30
    v_fmac_f32 v23, v25, v30
    v_cvt_pk_bf16_f32 v20, v22, v23
    v_and_b32 v28, 31, v0
    v_lshlrev_b32 v28, 2, v28
    ds_write_b32 v28, v20 offset:6528
    v_lshrrev_b32 v28, 3, v0
    v_lshlrev_b32 v28, 4, v28
    ds_read_b128 v[12:15], v28 offset:6528
    s_getreg_b32 s32, hwreg(HW_REG_XCC_ID, 0, 4)
    s_waitcnt lgkmcnt(0)
    s_add_u32 s30, s30, 0x9E3779B9
    s_add_u32 s31, s31, 0x7F4A7C00
    s_and_b32 s31, s31, 0xFFFFFFE0
    s_or_b32 s31, s31, 0x10
    s_mov_b32 s36, s30
    s_or_b32 s37, s31, s32
    s_and_b32 s52, s30, 0x3ff
    s_bfe_u32 s53, s30, 0xA000A
    s_bfe_u32 s54, s30, 0xA0014
    s_bfe_u32 s55, s31, 0xA0008
    s_movk_i32 s56, 0x3ff
    s_mov_b32 s57, 0xfffffc00
    v_lshlrev_b32 v3, 4, v0
    v_add_u32 v38, 90112, v3
    v_perm_b32 v104, v12, v12, v168
    v_perm_b32 v105, v12, v12, v169
    v_perm_b32 v106, v12, v12, v170
    v_perm_b32 v107, v12, v12, v171
    v_perm_b32 v108, v12, v12, v172
    v_perm_b32 v109, v12, v12, v173
    v_perm_b32 v110, v12, v12, v174
    v_perm_b32 v111, v12, v12, v175
    v_perm_b32 v112, v13, v13, v168
    v_perm_b32 v113, v13, v13, v169
    v_perm_b32 v114, v13, v13, v170
    v_perm_b32 v115, v13, v13, v171
    v_perm_b32 v116, v13, v13, v172
    v_perm_b32 v117, v13, v13, v173
    v_perm_b32 v118, v13, v13, v174
    v_perm_b32 v119, v13, v13, v175
    v_perm_b32 v120, v14, v14, v168
    v_perm_b32 v121, v14, v14, v169
    v_perm_b32 v122, v14, v14, v170
    v_perm_b32 v123, v14, v14, v171
    v_perm_b32 v124, v14, v14, v172
    v_perm_b32 v125, v14, v14, v173
    v_perm_b32 v126, v14, v14, v174
    v_perm_b32 v127, v14, v14, v175
    v_perm_b32 v128, v15, v15, v168
    v_perm_b32 v129, v15, v15, v169
    v_perm_b32 v130, v15, v15, v170
    v_perm_b32 v131, v15, v15, v171
    v_perm_b32 v132, v15, v15, v172
    v_perm_b32 v133, v15, v15, v173
    v_perm_b32 v134, v15, v15, v174
    v_perm_b32 v135, v15, v15, v175
    v_lshrrev_b32 v3, 4, v0
    v_lshlrev_b32 v3, 3, v3
    v_and_b32 v36, 7, v0
    v_add_u32 v3, v3, v36
    v_lshl_add_u32 v3, v3, 4, s44
    s_lshr_b32 s41, s27, 3
    s_lshl_b32 s41, s41, 12
    s_lshl_b32 s42, s26, 14
    s_add_u32 s41, s41, s42
    s_add_u32 s41, s41, 524288
    v_lshl_add_u32 v4, v0, 4, s41
    s_waitcnt vmcnt(0)
    v_mfma_f32_16x16x32_bf16 v[176:179], v[104:107], v[48:51], 0
    v_mfma_f32_16x16x32_bf16 v[176:179], v[108:111], v[52:55], v[176:179]
    v_mfma_f32_16x16x32_bf16 v[176:179], v[112:115], v[56:59], v[176:179]
    v_mfma_f32_16x16x32_bf16 v[176:179], v[116:119], v[60:63], v[176:179]
    v_mfma_f32_16x16x32_bf16 v[176:179], v[120:123], v[64:67], v[176:179]
    v_mfma_f32_16x16x32_bf16 v[176:179], v[124:127], v[68:71], v[176:179]
    v_mfma_f32_16x16x32_bf16 v[176:179], v[128:131], v[72:75], v[176:179]
    v_mfma_f32_16x16x32_bf16 v[176:179], v[132:135], v[76:79], v[176:179]
    s_nop 7
    v_permlane32_swap_b32 v176, v178
    v_permlane32_swap_b32 v177, v179
    s_nop 1
    v_add_f32_dpp v176, v178, v176 row_ror:8 row_mask:0xf bank_mask:0xf
    v_add_f32_dpp v177, v179, v177 row_ror:8 row_mask:0xf bank_mask:0xf
    v_mov_b32 v178, s30
    v_mov_b32 v179, s31
    v_add_u32 v5, 4194304, v3
    s_mov_b32 s42, 0x00ff00ff
    s_mov_b32 s43, 0x00ff00ff
    s_mov_b64 exec, s[42:43]
    global_store_dwordx4 v3, v[176:179], s[24:25]
    s_mov_b64 exec, -1
    s_mov_b64 exec, 1
    ds_add_u32 v1, v2 offset:6844
    s_mov_b64 exec, -1
    s_mov_b32 s39, 0
W_8:
    ds_read_b32 v180, v1 offset:6792
    s_waitcnt lgkmcnt(0)
    v_readfirstlane_b32 s40, v180
    s_cmp_ge_u32 s40, 1
    s_cbranch_scc1 W_9
    s_sleep 1
    s_add_u32 s39, s39, 1
    s_cmp_lt_u32 s39, 1048576
    s_cbranch_scc1 W_8
    s_branch L_end
W_9:
    ds_read_b32 v180, v1 offset:6796
    s_waitcnt lgkmcnt(0)
    v_readfirstlane_b32 s33, v180
    s_min_u32 s33, s33, 1
    s_mul_i32 s40, s33, 4194304
    s_add_u32 s34, s24, s40
    s_addc_u32 s35, s25, 0
    s_cmp_eq_u32 s33, 0
    s_cbranch_scc1 H_10
    s_mov_b64 exec, s[42:43]
    global_store_dwordx4 v5, v[176:179], s[24:25] sc1
    s_mov_b64 exec, -1
H_10:
    s_mov_b32 s39, 0
P_11:
    global_load_dwordx4 v[8:11], v4, s[34:35] offset:0 sc1
    global_load_dwordx4 v[12:15], v4, s[34:35] offset:1024 sc1
    global_load_dwordx4 v[16:19], v4, s[34:35] offset:2048 sc1
    global_load_dwordx4 v[20:23], v4, s[34:35] offset:3072 sc1
    s_waitcnt vmcnt(3)
    v_cmp_ne_u64 vcc, v[10:11], s[30:31]
    s_waitcnt vmcnt(2)
    v_cmp_ne_u64 s[40:41], v[14:15], s[30:31]
    s_or_b64 vcc, vcc, s[40:41]
    s_waitcnt vmcnt(1)
    v_cmp_ne_u64 s[40:41], v[18:19], s[30:31]
    s_or_b64 vcc, vcc, s[40:41]
    s_waitcnt vmcnt(0)
    v_cmp_ne_u64 s[40:41], v[22:23], s[30:31]
    s_or_b64 vcc, vcc, s[40:41]
    s_cbranch_vccz P_12
    s_add_u32 s39, s39, 1
    s_cmp_le_u32 s39, 65536
    s_cbranch_scc1 P_11
    s_branch L_end
P_12:
    v_add_f32 v8, v8, v12
    v_add_f32 v16, v16, v20
    v_add_f32 v9, v9, v13
    v_add_f32 v17, v17, v21
    v_add_f32 v8, v8, v16
    v_add_f32 v9, v9, v17
    v_mov_b32 v180, v8
    v_mov_b32 v181, v9
    s_nop 0
    v_permlane32_swap_b32 v8, v180
    v_permlane32_swap_b32 v9, v181
    v_add_f32 v8, v8, v180
    v_add_f32 v9, v9, v181
    v_max_f32 v8, 0, v8
    v_max_f32 v9, 0, v9
    v_cvt_pk_bf16_f32 v8, v8, v9
    v_and_b32 v5, 7, v0
    v_lshlrev_b32 v5, 4, v5
    v_bfe_u32 v6, v0, 3, 1
    v_lshl_add_u32 v5, v6, 3, v5
    v_bfe_u32 v6, v0, 4, 1
    v_lshl_add_u32 v5, v6, 2, v5
    ds_write_b32 v5, v8 offset:6528
    v_lshrrev_b32 v5, 3, v0
    v_lshlrev_b32 v5, 4, v5
    ds_read_b128 v[12:15], v5 offset:6528
    s_and_b32 s41, s27, 7
    s_lshr_b32 s42, s41, 1
    s_lshl_b32 s42, s42, 3
    s_and_b32 s41, s41, 1
    s_lshl_b32 s41, s41, 1
    s_add_u32 s41, s41, s42
    s_lshl_b32 s41, s41, 9
    s_lshl_b32 s42, s26, 14
    s_add_u32 s41, s41, s42
    s_lshr_b32 s42, s27, 3
    s_lshl_b32 s42, s42, 7
    s_add_u32 s41, s41, s42
    s_add_u32 s41, s41, 3145728
    v_bfe_u32 v3, v0, 4, 1
    v_lshlrev_b32 v3, 11, v3
    v_bfe_u32 v5, v0, 2, 1
    v_lshl_add_u32 v3, v5, 9, v3
    v_lshrrev_b32 v5, 5, v0
    v_lshl_add_u32 v3, v5, 6, v3
    v_and_b32 v5, 3, v0
    v_lshl_add_u32 v3, v5, 4, v3
    v_add_u32 v3, s41, v3
    s_waitcnt lgkmcnt(0)
    v_perm_b32 v104, v12, v12, v168
    v_perm_b32 v105, v12, v12, v169
    v_perm_b32 v106, v12, v12, v170
    v_perm_b32 v107, v12, v12, v171
    v_perm_b32 v108, v12, v12, v172
    v_perm_b32 v109, v12, v12, v173
    v_perm_b32 v110, v12, v12, v174
    v_perm_b32 v111, v12, v12, v175
    v_perm_b32 v112, v13, v13, v168
    v_perm_b32 v113, v13, v13, v169
    v_perm_b32 v114, v13, v13, v170
    v_perm_b32 v115, v13, v13, v171
    v_perm_b32 v116, v13, v13, v172
    v_perm_b32 v117, v13, v13, v173
    v_perm_b32 v118, v13, v13, v174
    v_perm_b32 v119, v13, v13, v175
    v_perm_b32 v120, v14, v14, v168
    v_perm_b32 v121, v14, v14, v169
    v_perm_b32 v122, v14, v14, v170
    v_perm_b32 v123, v14, v14, v171
    v_perm_b32 v124, v14, v14, v172
    v_perm_b32 v125, v14, v14, v173
    v_perm_b32 v126, v14, v14, v174
    v_perm_b32 v127, v14, v14, v175
    v_perm_b32 v128, v15, v15, v168
    v_perm_b32 v129, v15, v15, v169
    v_perm_b32 v130, v15, v15, v170
    v_perm_b32 v131, v15, v15, v171
    v_perm_b32 v132, v15, v15, v172
    v_perm_b32 v133, v15, v15, v173
    v_perm_b32 v134, v15, v15, v174
    v_perm_b32 v135, v15, v15, v175
    s_mov_b32 s39, 0
W_13:
    ds_read_b32 v180, v1 offset:6840
    s_waitcnt lgkmcnt(0)
    v_readfirstlane_b32 s40, v180
    s_cmp_ge_u32 s40, 1
    s_cbranch_scc1 W_14
    s_sleep 1
    s_add_u32 s39, s39, 1
    s_cmp_lt_u32 s39, 1048576
    s_cbranch_scc1 W_13
    s_branch L_end
W_14:
    ds_read_b128 v[40:43], v38 offset:0
    ds_read_b128 v[44:47], v38 offset:1024
    ds_read_b128 v[48:51], v38 offset:2048
    ds_read_b128 v[52:55], v38 offset:3072
    ds_read_b128 v[56:59], v38 offset:4096
    ds_read_b128 v[60:63], v38 offset:5120
    ds_read_b128 v[64:67], v38 offset:6144
    ds_read_b128 v[68:71], v38 offset:7168
    s_waitcnt lgkmcnt(7)
    v_mfma_f32_16x16x32_bf16 v[176:179], v[104:107], v[40:43], 0
    s_waitcnt lgkmcnt(6)
    v_mfma_f32_16x16x32_bf16 v[176:179], v[108:111], v[44:47], v[176:179]
    s_waitcnt lgkmcnt(5)
    v_mfma_f32_16x16x32_bf16 v[176:179], v[112:115], v[48:51], v[176:179]
    s_waitcnt lgkmcnt(4)
    v_mfma_f32_16x16x32_bf16 v[176:179], v[116:119], v[52:55], v[176:179]
    s_waitcnt lgkmcnt(3)
    v_mfma_f32_16x16x32_bf16 v[176:179], v[120:123], v[56:59], v[176:179]
    s_waitcnt lgkmcnt(2)
    v_mfma_f32_16x16x32_bf16 v[176:179], v[124:127], v[60:63], v[176:179]
    s_waitcnt lgkmcnt(1)
    v_mfma_f32_16x16x32_bf16 v[176:179], v[128:131], v[64:67], v[176:179]
    s_waitcnt lgkmcnt(0)
    v_mfma_f32_16x16x32_bf16 v[176:179], v[132:135], v[68:71], v[176:179]
    s_nop 7
    v_permlane32_swap_b32 v176, v178
    v_permlane32_swap_b32 v177, v179
    s_nop 1
    v_add_f32_dpp v176, v178, v176 row_ror:8 row_mask:0xf bank_mask:0xf
    v_add_f32_dpp v177, v179, v177 row_ror:8 row_mask:0xf bank_mask:0xf
    v_mov_b32 v178, s30
    v_mov_b32 v179, s31
    s_mov_b32 s42, 0x00ff00ff
    s_mov_b32 s43, 0x00ff00ff
    s_mov_b64 exec, s[42:43]
    s_cmp_lg_u32 s33, 0
    s_cbranch_scc1 S_15
    global_store_dwordx4 v3, v[176:179], s[34:35]
    s_branch S_16
S_15:
    global_store_dwordx4 v3, v[176:179], s[34:35] sc1
S_16:
    s_mov_b64 exec, -1
    s_endpgm
L_C2:
    v_mov_b32 v1, 0
    v_mov_b32 v2, 1
    s_setprio 3
    v_lshlrev_b32 v3, 2, v0
    ds_write_b32 v3, v1 offset:6784
    s_waitcnt lgkmcnt(0)
    s_load_dwordx2 s[30:31], s[24:25], 0
    s_barrier
    s_cmp_lt_u32 s26, 4
    s_cselect_b32 s49, 32, 24
    s_cmp_lt_u32 s27, s49
    s_cselect_b32 s38, 1, 0
    s_mul_i32 s50, s26, 4
    s_sub_u32 s51, s26, 4
    s_mul_i32 s51, s51, 3
    s_add_u32 s51, s51, 16
    s_cmp_lt_u32 s26, 4
    s_cselect_b32 s50, s50, s51
    s_lshr_b32 s51, s27, 3
    s_add_u32 s50, s50, s51
    s_max_u32 s45, s27, 28
    s_sub_u32 s45, s45, 28
    s_lshl_b32 s45, s45, 3
    s_add_u32 s45, s45, s26
    s_lshr_b32 s41, s45, 3
    s_lshl_b32 s41, s41, 7
    s_and_b32 s42, s45, 3
    s_lshl_b32 s42, s42, 5
    s_add_u32 s41, s41, s42
    s_bfe_u32 s42, s45, 0x10002
    s_lshl_b32 s42, s42, 2
    s_add_u32 s41, s41, s42
    v_and_b32 v3, 3, v0
    v_lshlrev_b32 v3, 3, v3
    v_bfe_u32 v83, v0, 2, 1
    v_lshl_add_u32 v3, v83, 1, v3
    v_add_u32 v3, s41, v3
    v_lshlrev_b32 v82, 1, v3
    s_lshl_b32 s41, s45, 11
    s_add_u32 s41, s41, 458752
    v_lshrrev_b32 v3, 3, v0
    v_lshlrev_b32 v3, 8, v3
    v_and_b32 v83, 7, v0
    v_lshl_add_u32 v3, v83, 4, v3
    v_add_u32 v81, s41, v3
    s_cmp_lt_u32 s27, 28
    s_cbranch_scc1 NF_17
    global_load_dword v80, v82, s[4:5]
    global_load_dwordx4 v[84:87], v81, s[24:25] sc1
    global_load_dwordx4 v[88:91], v81, s[24:25] offset:128 sc1
NF_17:
    s_lshl_b32 s41, s26, 14
    s_add_u32 s41, s41, 65536
    v_lshl_add_u32 v4, v0, 4, s41
    v_add_u32 v5, 0x1000, v4
    v_add_u32 v6, 0x2000, v4
    v_add_u32 v7, 0x3000, v4
    s_getreg_b32 s32, hwreg(HW_REG_XCC_ID, 0, 4)
    s_waitcnt lgkmcnt(0)
    s_add_u32 s30, s30, 0x9E3779B9
    s_add_u32 s31, s31, 0x7F4A7C00
    s_and_b32 s31, s31, 0xFFFFFFE0
    s_or_b32 s31, s31, 0x10
    s_mov_b32 s36, s30
    s_or_b32 s37, s31, s32
    s_and_b32 s52, s30, 0x3ff
    s_bfe_u32 s53, s30, 0xA000A
    s_bfe_u32 s54, s30, 0xA0014
    s_bfe_u32 s55, s31, 0xA0008
    s_movk_i32 s56, 0x3ff
    s_mov_b32 s57, 0xfffffc00
    s_mov_b32 s39, 0
W_18:
    ds_read_b32 v100, v1 offset:6816
    s_waitcnt lgkmcnt(0)
    v_readfirstlane_b32 s40, v100
    s_cmp_ge_u32 s40, 1
    s_cbranch_scc1 W_19
    s_sleep 1
    s_add_u32 s39, s39, 1
    s_cmp_lt_u32 s39, 1048576
    s_cbranch_scc1 W_18
    s_branch L_end
W_19:
    s_mov_b32 s39, 0
P_22:
    global_load_dwordx4 v[8:11], v4, s[24:25] offset:0 sc1
    global_load_dwordx4 v[12:15], v5, s[24:25] offset:0 sc1
    global_load_dwordx4 v[16:19], v6, s[24:25] offset:0 sc1
    global_load_dwordx4 v[20:23], v7, s[24:25] offset:0 sc1
    global_load_dwordx4 v[24:27], v4, s[24:25] offset:1024 sc1
    global_load_dwordx4 v[28:31], v5, s[24:25] offset:1024 sc1
    global_load_dwordx4 v[32:35], v6, s[24:25] offset:1024 sc1
    global_load_dwordx4 v[36:39], v7, s[24:25] offset:1024 sc1
    global_load_dwordx4 v[40:43], v4, s[24:25] offset:2048 sc1
    global_load_dwordx4 v[44:47], v5, s[24:25] offset:2048 sc1
    global_load_dwordx4 v[48:51], v6, s[24:25] offset:2048 sc1
    global_load_dwordx4 v[52:55], v7, s[24:25] offset:2048 sc1
    global_load_dwordx4 v[56:59], v4, s[24:25] offset:3072 sc1
    global_load_dwordx4 v[60:63], v5, s[24:25] offset:3072 sc1
    global_load_dwordx4 v[64:67], v6, s[24:25] offset:3072 sc1
    global_load_dwordx4 v[68:71], v7, s[24:25] offset:3072 sc1
    s_waitcnt vmcnt(15)
    v_cmp_ne_u64 vcc, v[10:11], s[36:37]
    s_waitcnt vmcnt(14)
    v_cmp_ne_u64 s[40:41], v[14:15], s[36:37]
    s_or_b64 vcc, vcc, s[40:41]
    s_waitcnt vmcnt(13)
    v_cmp_ne_u64 s[40:41], v[18:19], s[36:37]
    s_or_b64 vcc, vcc, s[40:41]
    s_waitcnt vmcnt(12)
    v_cmp_ne_u64 s[40:41], v[22:23], s[36:37]
    s_or_b64 vcc, vcc, s[40:41]
    s_waitcnt vmcnt(11)
    v_cmp_ne_u64 s[40:41], v[26:27], s[36:37]
    s_or_b64 vcc, vcc, s[40:41]
    s_waitcnt vmcnt(10)
    v_cmp_ne_u64 s[40:41], v[30:31], s[36:37]
    s_or_b64 vcc, vcc, s[40:41]
    s_waitcnt vmcnt(9)
    v_cmp_ne_u64 s[40:41], v[34:35], s[36:37]
    s_or_b64 vcc, vcc, s[40:41]
    s_waitcnt vmcnt(8)
    v_cmp_ne_u64 s[40:41], v[38:39], s[36:37]
    s_or_b64 vcc, vcc, s[40:41]
    s_waitcnt vmcnt(7)
    v_cmp_ne_u64 s[40:41], v[42:43], s[36:37]
    s_or_b64 vcc, vcc, s[40:41]
    s_waitcnt vmcnt(6)
    v_cmp_ne_u64 s[40:41], v[46:47], s[36:37]
    s_or_b64 vcc, vcc, s[40:41]
    s_waitcnt vmcnt(5)
    v_cmp_ne_u64 s[40:41], v[50:51], s[36:37]
    s_or_b64 vcc, vcc, s[40:41]
    s_waitcnt vmcnt(4)
    v_cmp_ne_u64 s[40:41], v[54:55], s[36:37]
    s_or_b64 vcc, vcc, s[40:41]
    s_waitcnt vmcnt(3)
    v_cmp_ne_u64 s[40:41], v[58:59], s[36:37]
    s_or_b64 vcc, vcc, s[40:41]
    s_waitcnt vmcnt(2)
    v_cmp_ne_u64 s[40:41], v[62:63], s[36:37]
    s_or_b64 vcc, vcc, s[40:41]
    s_waitcnt vmcnt(1)
    v_cmp_ne_u64 s[40:41], v[66:67], s[36:37]
    s_or_b64 vcc, vcc, s[40:41]
    s_waitcnt vmcnt(0)
    v_cmp_ne_u64 s[40:41], v[70:71], s[36:37]
    s_or_b64 vcc, vcc, s[40:41]
    s_cbranch_vccz P_23
    s_add_u32 s39, s39, 1
    s_cmp_le_u32 s39, 8
    s_cbranch_scc1 P_22
    s_branch Q_20
P_23:
    s_branch Q_21
Q_20:
    s_waitcnt vmcnt(0)
    s_add_u32 s46, s24, 4194304
    s_addc_u32 s47, s25, 0
    s_lshl_b32 s41, s26, 14
    s_lshr_b32 s42, s27, 3
    s_lshl_b32 s42, s42, 12
    s_add_u32 s41, s41, s42
    s_and_b32 s42, s27, 7
    s_lshl_b32 s42, s42, 9
    s_add_u32 s41, s41, s42
    s_add_u32 s41, s41, 65536
    v_and_b32 v76, 31, v0
    v_lshl_add_u32 v76, v76, 4, s41
    global_load_dwordx4 v[72:75], v76, s[24:25] sc1
    s_waitcnt vmcnt(0)
    global_store_dwordx4 v76, v[72:75], s[46:47] sc1
    s_mov_b32 s39, 0
P_24:
    global_load_dwordx4 v[8:11], v4, s[46:47] offset:0 sc1
    global_load_dwordx4 v[12:15], v5, s[46:47] offset:0 sc1
    global_load_dwordx4 v[16:19], v6, s[46:47] offset:0 sc1
    global_load_dwordx4 v[20:23], v7, s[46:47] offset:0 sc1
    global_load_dwordx4 v[24:27], v4, s[46:47] offset:1024 sc1
    global_load_dwordx4 v[28:31], v5, s[46:47] offset:1024 sc1
    global_load_dwordx4 v[32:35], v6, s[46:47] offset:1024 sc1
    global_load_dwordx4 v[36:39], v7, s[46:47] offset:1024 sc1
    global_load_dwordx4 v[40:43], v4, s[46:47] offset:2048 sc1
    global_load_dwordx4 v[44:47], v5, s[46:47] offset:2048 sc1
    global_load_dwordx4 v[48:51], v6, s[46:47] offset:2048 sc1
    global_load_dwordx4 v[52:55], v7, s[46:47] offset:2048 sc1
    global_load_dwordx4 v[56:59], v4, s[46:47] offset:3072 sc1
    global_load_dwordx4 v[60:63], v5, s[46:47] offset:3072 sc1
    global_load_dwordx4 v[64:67], v6, s[46:47] offset:3072 sc1
    global_load_dwordx4 v[68:71], v7, s[46:47] offset:3072 sc1
    s_add_u32 s39, s39, 1
    s_cmp_gt_u32 s39, 65536
    s_cbranch_scc1 L_end
    s_waitcnt vmcnt(0)
    v_mov_b32 v100, 0
    v_mov_b32 v101, 0
    v_xor_b32 v102, s30, v10
    v_xor_b32 v103, s31, v11
    v_and_b32 v103, 0xfffffff0, v103
    v_or3_b32 v100, v100, v102, v103
    v_xor_b32 v103, s37, v11
    v_or_b32 v101, v101, v103
    v_xor_b32 v102, s30, v14
    v_xor_b32 v103, s31, v15
    v_and_b32 v103, 0xfffffff0, v103
    v_or3_b32 v100, v100, v102, v103
    v_xor_b32 v103, s37, v15
    v_or_b32 v101, v101, v103
    v_xor_b32 v102, s30, v18
    v_xor_b32 v103, s31, v19
    v_and_b32 v103, 0xfffffff0, v103
    v_or3_b32 v100, v100, v102, v103
    v_xor_b32 v103, s37, v19
    v_or_b32 v101, v101, v103
    v_xor_b32 v102, s30, v22
    v_xor_b32 v103, s31, v23
    v_and_b32 v103, 0xfffffff0, v103
    v_or3_b32 v100, v100, v102, v103
    v_xor_b32 v103, s37, v23
    v_or_b32 v101, v101, v103
    v_xor_b32 v102, s30, v26
    v_xor_b32 v103, s31, v27
    v_and_b32 v103, 0xfffffff0, v103
    v_or3_b32 v100, v100, v102, v103
    v_xor_b32 v103, s37, v27
    v_or_b32 v101, v101, v103
    v_xor_b32 v102, s30, v30
    v_xor_b32 v103, s31, v31
    v_and_b32 v103, 0xfffffff0, v103
    v_or3_b32 v100, v100, v102, v103
    v_xor_b32 v103, s37, v31
    v_or_b32 v101, v101, v103
    v_xor_b32 v102, s30, v34
    v_xor_b32 v103, s31, v35
    v_and_b32 v103, 0xfffffff0, v103
    v_or3_b32 v100, v100, v102, v103
    v_xor_b32 v103, s37, v35
    v_or_b32 v101, v101, v103
    v_xor_b32 v102, s30, v38
    v_xor_b32 v103, s31, v39
    v_and_b32 v103, 0xfffffff0, v103
    v_or3_b32 v100, v100, v102, v103
    v_xor_b32 v103, s37, v39
    v_or_b32 v101, v101, v103
    v_xor_b32 v102, s30, v42
    v_xor_b32 v103, s31, v43
    v_and_b32 v103, 0xfffffff0, v103
    v_or3_b32 v100, v100, v102, v103
    v_xor_b32 v103, s37, v43
    v_or_b32 v101, v101, v103
    v_xor_b32 v102, s30, v46
    v_xor_b32 v103, s31, v47
    v_and_b32 v103, 0xfffffff0, v103
    v_or3_b32 v100, v100, v102, v103
    v_xor_b32 v103, s37, v47
    v_or_b32 v101, v101, v103
    v_xor_b32 v102, s30, v50
    v_xor_b32 v103, s31, v51
    v_and_b32 v103, 0xfffffff0, v103
    v_or3_b32 v100, v100, v102, v103
    v_xor_b32 v103, s37, v51
    v_or_b32 v101, v101, v103
    v_xor_b32 v102, s30, v54
    v_xor_b32 v103, s31, v55
    v_and_b32 v103, 0xfffffff0, v103
    v_or3_b32 v100, v100, v102, v103
    v_xor_b32 v103, s37, v55
    v_or_b32 v101, v101, v103
    v_xor_b32 v102, s30, v58
    v_xor_b32 v103, s31, v59
    v_and_b32 v103, 0xfffffff0, v103
    v_or3_b32 v100, v100, v102, v103
    v_xor_b32 v103, s37, v59
    v_or_b32 v101, v101, v103
    v_xor_b32 v102, s30, v62
    v_xor_b32 v103, s31, v63
    v_and_b32 v103, 0xfffffff0, v103
    v_or3_b32 v100, v100, v102, v103
    v_xor_b32 v103, s37, v63
    v_or_b32 v101, v101, v103
    v_xor_b32 v102, s30, v66
    v_xor_b32 v103, s31, v67
    v_and_b32 v103, 0xfffffff0, v103
    v_or3_b32 v100, v100, v102, v103
    v_xor_b32 v103, s37, v67
    v_or_b32 v101, v101, v103
    v_xor_b32 v102, s30, v70
    v_xor_b32 v103, s31, v71
    v_and_b32 v103, 0xfffffff0, v103
    v_or3_b32 v100, v100, v102, v103
    v_xor_b32 v103, s37, v71
    v_or_b32 v101, v101, v103
    v_cmp_ne_u32 vcc, 0, v100
    s_cbranch_vccz Q_26
    global_load_dwordx4 v[8:11], v4, s[24:25] offset:0 sc1
    global_load_dwordx4 v[12:15], v5, s[24:25] offset:0 sc1
    global_load_dwordx4 v[16:19], v6, s[24:25] offset:0 sc1
    global_load_dwordx4 v[20:23], v7, s[24:25] offset:0 sc1
    global_load_dwordx4 v[24:27], v4, s[24:25] offset:1024 sc1
    global_load_dwordx4 v[28:31], v5, s[24:25] offset:1024 sc1
    global_load_dwordx4 v[32:35], v6, s[24:25] offset:1024 sc1
    global_load_dwordx4 v[36:39], v7, s[24:25] offset:1024 sc1
    global_load_dwordx4 v[40:43], v4, s[24:25] offset:2048 sc1
    global_load_dwordx4 v[44:47], v5, s[24:25] offset:2048 sc1
    global_load_dwordx4 v[48:51], v6, s[24:25] offset:2048 sc1
    global_load_dwordx4 v[52:55], v7, s[24:25] offset:2048 sc1
    global_load_dwordx4 v[56:59], v4, s[24:25] offset:3072 sc1
    global_load_dwordx4 v[60:63], v5, s[24:25] offset:3072 sc1
    global_load_dwordx4 v[64:67], v6, s[24:25] offset:3072 sc1
    global_load_dwordx4 v[68:71], v7, s[24:25] offset:3072 sc1
    s_waitcnt vmcnt(15)
    v_cmp_ne_u64 vcc, v[10:11], s[36:37]
    s_waitcnt vmcnt(14)
    v_cmp_ne_u64 s[40:41], v[14:15], s[36:37]
    s_or_b64 vcc, vcc, s[40:41]
    s_waitcnt vmcnt(13)
    v_cmp_ne_u64 s[40:41], v[18:19], s[36:37]
    s_or_b64 vcc, vcc, s[40:41]
    s_waitcnt vmcnt(12)
    v_cmp_ne_u64 s[40:41], v[22:23], s[36:37]
    s_or_b64 vcc, vcc, s[40:41]
    s_waitcnt vmcnt(11)
    v_cmp_ne_u64 s[40:41], v[26:27], s[36:37]
    s_or_b64 vcc, vcc, s[40:41]
    s_waitcnt vmcnt(10)
    v_cmp_ne_u64 s[40:41], v[30:31], s[36:37]
    s_or_b64 vcc, vcc, s[40:41]
    s_waitcnt vmcnt(9)
    v_cmp_ne_u64 s[40:41], v[34:35], s[36:37]
    s_or_b64 vcc, vcc, s[40:41]
    s_waitcnt vmcnt(8)
    v_cmp_ne_u64 s[40:41], v[38:39], s[36:37]
    s_or_b64 vcc, vcc, s[40:41]
    s_waitcnt vmcnt(7)
    v_cmp_ne_u64 s[40:41], v[42:43], s[36:37]
    s_or_b64 vcc, vcc, s[40:41]
    s_waitcnt vmcnt(6)
    v_cmp_ne_u64 s[40:41], v[46:47], s[36:37]
    s_or_b64 vcc, vcc, s[40:41]
    s_waitcnt vmcnt(5)
    v_cmp_ne_u64 s[40:41], v[50:51], s[36:37]
    s_or_b64 vcc, vcc, s[40:41]
    s_waitcnt vmcnt(4)
    v_cmp_ne_u64 s[40:41], v[54:55], s[36:37]
    s_or_b64 vcc, vcc, s[40:41]
    s_waitcnt vmcnt(3)
    v_cmp_ne_u64 s[40:41], v[58:59], s[36:37]
    s_or_b64 vcc, vcc, s[40:41]
    s_waitcnt vmcnt(2)
    v_cmp_ne_u64 s[40:41], v[62:63], s[36:37]
    s_or_b64 vcc, vcc, s[40:41]
    s_waitcnt vmcnt(1)
    v_cmp_ne_u64 s[40:41], v[66:67], s[36:37]
    s_or_b64 vcc, vcc, s[40:41]
    s_waitcnt vmcnt(0)
    v_cmp_ne_u64 s[40:41], v[70:71], s[36:37]
    s_or_b64 vcc, vcc, s[40:41]
    s_cbranch_vccnz P_24
    s_branch Q_21
Q_26:
    v_cmp_ne_u32 vcc, 0, v101
    s_cbranch_vccz Q_21
    s_mov_b64 exec, 1
    ds_add_u32 v1, v2 offset:6796
    s_mov_b64 exec, -1
Q_21:
    v_add_f32 v8, v8, v12
    v_add_f32 v16, v16, v20
    v_add_f32 v9, v9, v13
    v_add_f32 v17, v17, v21
    v_add_f32 v8, v8, v16
    v_add_f32 v9, v9, v17
    v_cvt_pk_bf16_f32 v8, v8, v9
    v_add_f32 v24, v24, v28
    v_add_f32 v32, v32, v36
    v_add_f32 v25, v25, v29
    v_add_f32 v33, v33, v37
    v_add_f32 v24, v24, v32
    v_add_f32 v25, v25, v33
    v_cvt_pk_bf16_f32 v24, v24, v25
    v_add_f32 v40, v40, v44
    v_add_f32 v48, v48, v52
    v_add_f32 v41, v41, v45
    v_add_f32 v49, v49, v53
    v_add_f32 v40, v40, v48
    v_add_f32 v41, v41, v49
    v_cvt_pk_bf16_f32 v40, v40, v41
    v_add_f32 v56, v56, v60
    v_add_f32 v64, v64, v68
    v_add_f32 v57, v57, v61
    v_add_f32 v65, v65, v69
    v_add_f32 v56, v56, v64
    v_add_f32 v57, v57, v65
    v_cvt_pk_bf16_f32 v56, v56, v57
    v_lshrrev_b32 v72, 5, v0
    v_lshlrev_b32 v72, 7, v72
    v_and_b32 v73, 7, v0
    v_lshl_add_u32 v72, v73, 4, v72
    v_bfe_u32 v73, v0, 3, 1
    v_lshl_add_u32 v72, v73, 3, v72
    v_bfe_u32 v73, v0, 4, 1
    v_lshl_add_u32 v72, v73, 2, v72
    ds_write_b32 v72, v8 offset:0
    ds_write_b32 v72, v24 offset:320
    ds_write_b32 v72, v40 offset:640
    ds_write_b32 v72, v56 offset:960
    s_mov_b64 exec, 1
    ds_add_u32 v1, v2 offset:6792
    s_mov_b64 exec, -1
    s_lshl_b32 s41, s26, 15
    s_lshl_b32 s42, s27, 10
    s_add_u32 s41, s41, s42
    s_add_u32 s41, s41, 2097152
    v_lshl_add_u32 v4, v0, 4, s41
    s_lshl_b32 s41, s27, 11
    s_lshl_b32 s42, s26, 8
    s_add_u32 s41, s41, s42
    s_add_u32 s41, s41, 458752
    v_lshl_add_u32 v6, v0, 4, s41
    ds_read_b32 v100, v1 offset:6796
    s_waitcnt lgkmcnt(0)
    v_readfirstlane_b32 s33, v100
    s_min_u32 s33, s33, 1
    s_mul_i32 s40, s33, 4194304
    s_add_u32 s34, s24, s40
    s_addc_u32 s35, s25, 0
    v_mov_b32 v40, 0
    v_mov_b32 v41, 0
    s_cmp_eq_u32 s49, 0
    s_cbranch_scc1 NG_27
    s_lshl_b32 s41, s26, 14
    s_lshl_b32 s42, s27, 9
    s_add_u32 s41, s41, s42
    s_add_u32 s41, s41, 3145728
    s_lshr_b32 s42, s49, 3
    v_bfe_u32 v52, v0, 3, 2
    v_cmp_gt_u32 vcc, s42, v52
    v_and_b32 v53, 31, v0
    v_and_b32 v54, 7, v0
    v_cndmask_b32 v53, v54, v53, vcc
    v_lshl_add_u32 v44, v53, 4, s41
    v_mov_b32 v54, 1.0
    v_cndmask_b32 v48, v1, v54, vcc
    s_mov_b32 s39, 0
W_28:
    ds_read_b32 v100, v1 offset:6820
    s_waitcnt lgkmcnt(0)
    v_readfirstlane_b32 s40, v100
    s_cmp_ge_u32 s40, 4
    s_cbranch_scc1 W_29
    s_sleep 1
    s_add_u32 s39, s39, 1
    s_cmp_lt_u32 s39, 1048576
    s_cbranch_scc1 W_28
    s_branch L_end
W_29:
    global_load_dwordx4 v[60:63], v4, s[34:35] sc1
    s_mov_b32 s39, 0
P_30:
    global_load_dwordx4 v[24:27], v44, s[34:35] offset:0 sc1
    s_waitcnt vmcnt(0)
    v_cmp_ne_u64 vcc, v[26:27], s[30:31]
    s_cbranch_vccz P_31
    s_add_u32 s39, s39, 1
    s_cmp_le_u32 s39, 65536
    s_cbranch_scc1 P_30
    s_branch L_end
P_31:
    v_mul_f32 v40, v48, v24
    v_mul_f32 v41, v48, v25
    s_nop 1
    v_add_f32_dpp v40, v40, v40 row_ror:8 row_mask:0xf bank_mask:0xf
    v_add_f32_dpp v41, v41, v41 row_ror:8 row_mask:0xf bank_mask:0xf
    v_mov_b32 v100, v40
    v_mov_b32 v101, v41
    s_nop 0
    v_permlane16_swap_b32 v40, v100
    v_permlane16_swap_b32 v41, v101
    v_add_f32 v40, v40, v100
    v_add_f32 v41, v41, v101
NG_27:
    v_bfe_u32 v3, v0, 2, 1
    v_bfe_u32 v7, v0, 3, 1
    v_cmp_eq_u32 s[42:43], 1, v3
    v_cmp_eq_u32 s[58:59], 1, v7
    s_mov_b32 s39, 0
W_32:
    ds_read_b32 v100, v1 offset:6832
    s_waitcnt lgkmcnt(0)
    v_readfirstlane_b32 s40, v100
    s_cmp_ge_u32 s40, 4
    s_cbranch_scc1 W_33
    s_add_u32 s39, s39, 1
    s_cmp_lt_u32 s39, 1048576
    s_cbranch_scc1 W_32
    s_branch L_end
W_33:
    s_mov_b32 s39, 0
P_34:
    global_load_dwordx4 v[8:11], v4, s[34:35] offset:0 sc1
    s_waitcnt vmcnt(0)
    v_xor_b32 v101, s52, v8
    v_xor_b32 v102, s53, v9
    v_xor_b32 v103, s54, v10
    v_xor_b32 v104, s55, v11
    v_or3_b32 v100, v101, v102, v103
    v_or_b32 v100, v100, v104
    v_and_b32 v100, s56, v100
    v_cmp_ne_u32 vcc, 0, v100
    s_cbranch_vccz P_35
    s_add_u32 s39, s39, 1
    s_cmp_le_u32 s39, 65536
    s_cbranch_scc1 P_34
    s_branch L_end
P_35:
    v_and_b32 v8, s57, v8
    v_and_b32 v9, s57, v9
    v_and_b32 v10, s57, v10
    v_and_b32 v11, s57, v11
    s_nop 1
    v_add_f32_dpp v8, v8, v8 row_ror:4 row_mask:0xf bank_mask:0xf
    v_add_f32_dpp v9, v9, v9 row_ror:4 row_mask:0xf bank_mask:0xf
    v_add_f32_dpp v10, v10, v10 row_ror:4 row_mask:0xf bank_mask:0xf
    v_add_f32_dpp v11, v11, v11 row_ror:4 row_mask:0xf bank_mask:0xf
    s_nop 0
    v_add_f32_dpp v8, v8, v8 row_ror:8 row_mask:0xf bank_mask:0xf
    v_add_f32_dpp v9, v9, v9 row_ror:8 row_mask:0xf bank_mask:0xf
    v_add_f32_dpp v10, v10, v10 row_ror:8 row_mask:0xf bank_mask:0xf
    v_add_f32_dpp v11, v11, v11 row_ror:8 row_mask:0xf bank_mask:0xf
    v_mov_b32 v100, v8
    v_mov_b32 v101, v9
    v_mov_b32 v102, v10
    v_mov_b32 v103, v11
    v_permlane16_swap_b32 v8, v100
    v_permlane16_swap_b32 v9, v101
    v_permlane16_swap_b32 v10, v102
    v_permlane16_swap_b32 v11, v103
    v_add_f32 v8, v8, v100
    v_add_f32 v9, v9, v101
    v_add_f32 v10, v10, v102
    v_add_f32 v11, v11, v103
    v_mov_b32 v100, v8
    v_mov_b32 v101, v9
    v_mov_b32 v102, v10
    v_mov_b32 v103, v11
    v_permlane32_swap_b32 v8, v100
    v_permlane32_swap_b32 v9, v101
    v_permlane32_swap_b32 v10, v102
    v_permlane32_swap_b32 v11, v103
    v_add_f32 v8, v8, v100
    v_add_f32 v9, v9, v101
    v_add_f32 v10, v10, v102
    v_add_f32 v11, v11, v103
    v_cndmask_b32 v8, v8, v10, s[42:43]
    v_cndmask_b32 v9, v9, v11, s[42:43]
    v_mov_b32 v10, s30
    v_mov_b32 v11, s31
    v_cndmask_b32 v8, v8, v40, s[58:59]
    v_cndmask_b32 v9, v9, v41, s[58:59]
    s_mov_b64 exec, 0xffff
    global_store_dwordx4 v6, v[8:11], s[24:25] sc1
    s_mov_b64 exec, -1
    s_cmp_ge_u32 s27, 28
    s_cbranch_scc1 F_36
    s_endpgm
F_36:
    s_mov_b32 s39, 0
P_37:
    global_load_dwordx4 v[12:15], v81, s[24:25] offset:0 sc1
    global_load_dwordx4 v[16:19], v81, s[24:25] offset:128 sc1
    s_waitcnt vmcnt(1)
    v_cmp_ne_u64 vcc, v[14:15], s[30:31]
    s_waitcnt vmcnt(0)
    v_cmp_ne_u64 s[40:41], v[18:19], s[30:31]
    s_or_b64 vcc, vcc, s[40:41]
    s_cbranch_vccz P_38
    s_add_u32 s39, s39, 1
    s_cmp_le_u32 s39, 65536
    s_cbranch_scc1 P_37
    s_branch L_end
P_38:
    s_nop 1
    v_add_f32_dpp v12, v12, v12 row_ror:8 row_mask:0xf bank_mask:0xf
    v_add_f32_dpp v13, v13, v13 row_ror:8 row_mask:0xf bank_mask:0xf
    v_add_f32_dpp v16, v16, v16 row_ror:8 row_mask:0xf bank_mask:0xf
    v_add_f32_dpp v17, v17, v17 row_ror:8 row_mask:0xf bank_mask:0xf
    v_mov_b32 v100, v12
    v_mov_b32 v101, v13
    v_mov_b32 v102, v16
    v_mov_b32 v103, v17
    v_permlane16_swap_b32 v12, v100
    v_permlane16_swap_b32 v13, v101
    v_permlane16_swap_b32 v16, v102
    v_permlane16_swap_b32 v17, v103
    v_add_f32 v12, v12, v100
    v_add_f32 v13, v13, v101
    v_add_f32 v16, v16, v102
    v_add_f32 v17, v17, v103
    v_mov_b32 v100, v12
    v_mov_b32 v101, v13
    v_mov_b32 v102, v16
    v_mov_b32 v103, v17
    v_permlane32_swap_b32 v12, v100
    v_permlane32_swap_b32 v13, v101
    v_permlane32_swap_b32 v16, v102
    v_permlane32_swap_b32 v17, v103
    v_add_f32 v12, v12, v100
    v_add_f32 v13, v13, v101
    v_add_f32 v16, v16, v102
    v_add_f32 v17, v17, v103
    v_cvt_pk_bf16_f32 v12, v12, v13
    v_cvt_pk_bf16_f32 v16, v16, v17
    v_and_b32 v13, 0xffff0000, v12
    v_lshlrev_b32 v12, 16, v12
    v_and_b32 v17, 0xffff0000, v16
    v_lshlrev_b32 v16, 16, v16
    v_mul_f32 v20, 0xbfb8aa3b, v16
    v_mul_f32 v21, 0xbfb8aa3b, v17
    v_exp_f32 v20, v20
    v_exp_f32 v21, v21
    s_nop 0
    v_add_f32 v20, 1.0, v20
    v_add_f32 v21, 1.0, v21
    v_rcp_f32 v20, v20
    v_rcp_f32 v21, v21
    s_nop 0
    v_mul_f32 v16, v16, v20
    v_mul_f32 v17, v17, v21
    v_cvt_pk_bf16_f32 v16, v16, v17
    v_and_b32 v17, 0xffff0000, v16
    v_lshlrev_b32 v16, 16, v16
    v_mul_f32 v12, v12, v16
    v_mul_f32 v13, v13, v17
    v_cvt_pk_bf16_f32 v12, v12, v13
    v_and_b32 v13, 0xffff0000, v12
    v_lshlrev_b32 v12, 16, v12
    v_and_b32 v17, 0xffff0000, v80
    v_lshlrev_b32 v16, 16, v80
    v_add_f32 v12, v12, v16
    v_add_f32 v13, v13, v17
    v_cvt_pk_bf16_f32 v12, v12, v13
    s_mov_b64 exec, 0xff
    global_store_dword v82, v12, s[20:21]
    s_cmp_lg_u32 s45, 0
    s_cbranch_scc1 E_39
    s_mov_b64 exec, 1
    v_mov_b32 v14, s30
    v_mov_b32 v15, s31
    global_store_dwordx2 v1, v[14:15], s[24:25] offset:0 sc1
E_39:
    s_mov_b64 exec, -1
    s_endpgm
L_A:
    v_mov_b32 v1, 0
    v_mov_b32 v2, 1
    s_barrier
    s_waitcnt lgkmcnt(0)
    s_load_dwordx2 s[30:31], s[24:25], 0
    s_setprio 1
    v_lshrrev_b32 v3, 4, v0
    v_and_b32 v4, 15, v0
    s_lshl_b32 s41, s28, 13
    v_and_b32 v5, 3, v4
    v_lshrrev_b32 v6, 2, v4
    v_lshlrev_b32 v7, 11, v6
    v_lshl_add_u32 v7, v5, 8, v7
    v_xor_b32 v8, v3, v5
    v_lshl_add_u32 v7, v8, 4, v7
    v_add_u32 v7, s41, v7
    v_xor_b32 v8, 0, v6
    v_lshl_add_u32 v16, v8, 6, v7
    v_xor_b32 v8, 1, v6
    v_lshl_add_u32 v17, v8, 6, v7
    v_xor_b32 v8, 2, v6
    v_lshl_add_u32 v18, v8, 6, v7
    v_xor_b32 v8, 3, v6
    v_lshl_add_u32 v19, v8, 6, v7
    v_mul_u32_u24 v8, 320, v6
    v_lshl_add_u32 v24, v3, 4, v8
    v_lshrrev_b32 v8, 2, v4
    v_and_b32 v9, 3, v4
    v_and_b32 v10, 1, v3
    v_lshl_or_b32 v10, v10, 2, v8
    v_lshl_add_u32 v11, v3, 3, v8
    v_lshlrev_b32 v11, 8, v11
    v_lshl_add_u32 v11, v9, 3, v11
    v_add_u32 v11, 40960, v11
    s_lshl_b32 s42, s28, 1
    s_add_u32 s43, s42, 0
    v_xor_b32 v12, s43, v10
    v_lshl_add_u32 v20, v12, 5, v11
    s_add_u32 s43, s42, 1
    v_xor_b32 v12, s43, v10
    v_lshl_add_u32 v21, v12, 5, v11
    s_lshl_b32 s42, s28, 12
    s_add_u32 s42, s42, 73728
    v_lshl_add_u32 v22, v0, 4, s42
    v_and_b32 v5, 15, v0
    v_and_b32 v6, 1, v5
    v_bfe_u32 v7, v5, 1, 2
    v_cmp_eq_u32 vcc, 1, v6
    v_mov_b32 v8, 0x0c0c0100
    v_mov_b32 v9, 0x01000c0c
    v_cndmask_b32 v10, v8, v9, vcc
    v_mov_b32 v8, 0x0c0c0302
    v_mov_b32 v9, 0x03020c0c
    v_cndmask_b32 v11, v8, v9, vcc
    v_mov_b32 v8, 0x0c0c0c0c
    v_cmp_eq_u32 vcc, 0, v7
    s_nop 1
    v_cndmask_b32 v28, v8, v10, vcc
    v_cndmask_b32 v32, v8, v11, vcc
    v_cmp_eq_u32 vcc, 1, v7
    s_nop 1
    v_cndmask_b32 v29, v8, v10, vcc
    v_cndmask_b32 v33, v8, v11, vcc
    v_cmp_eq_u32 vcc, 2, v7
    s_nop 1
    v_cndmask_b32 v30, v8, v10, vcc
    v_cndmask_b32 v34, v8, v11, vcc
    v_cmp_eq_u32 vcc, 3, v7
    s_nop 1
    v_cndmask_b32 v31, v8, v10, vcc
    v_cndmask_b32 v35, v8, v11, vcc
    s_getreg_b32 s32, hwreg(HW_REG_XCC_ID, 0, 4)
    s_waitcnt lgkmcnt(0)
    s_add_u32 s30, s30, 0x9E3779B9
    s_add_u32 s31, s31, 0x7F4A7C00
    s_and_b32 s31, s31, 0xFFFFFFE0
    s_or_b32 s31, s31, 0x10
    s_mov_b32 s36, s30
    s_or_b32 s37, s31, s32
    s_and_b32 s52, s30, 0x3ff
    s_bfe_u32 s53, s30, 0xA000A
    s_bfe_u32 s54, s30, 0xA0014
    s_bfe_u32 s55, s31, 0xA0008
    s_movk_i32 s56, 0x3ff
    s_mov_b32 s57, 0xfffffc00
    v_mov_b32 v38, s30
    v_mov_b32 v39, s31
    s_lshl_b32 s42, s26, 16
    s_lshl_b32 s43, s27, 7
    s_add_u32 s42, s42, s43
    s_add_u32 s42, s42, 1048576
    v_bfe_u32 v12, v0, 1, 3
    v_lshlrev_b32 v12, 4, v12
    v_lshlrev_b32 v13, 2, v3
    v_add_u32 v13, s28, v13
    v_lshl_add_u32 v13, v13, 12, v12
    v_add_u32 v40, s42, v13
    s_lshl_b32 s42, s26, 15
    s_lshr_b32 s43, s27, 1
    s_lshl_b32 s43, s43, 6
    s_add_u32 s42, s42, s43
    s_and_b32 s43, s27, 1
    s_lshl_b32 s43, s43, 14
    s_add_u32 s42, s42, s43
    s_lshr_b32 s43, s28, 1
    s_lshl_b32 s43, s43, 13
    s_add_u32 s42, s42, s43
    s_and_b32 s43, s28, 1
    s_lshl_b32 s43, s43, 11
    s_add_u32 s42, s42, s43
    s_add_u32 s42, s42, 2097152
    v_bfe_u32 v12, v0, 4, 1
    v_lshlrev_b32 v12, 12, v12
    v_bfe_u32 v13, v0, 2, 1
    v_lshl_add_u32 v12, v13, 10, v12
    v_and_b32 v13, 3, v0
    v_lshl_add_u32 v12, v13, 4, v12
    v_add_u32 v41, s42, v12
    s_lshl_b32 s42, s26, 11
    s_lshl_b32 s43, s27, 4
    s_add_u32 s42, s42, s43
    s_add_u32 s42, s42, 327680
    v_lshl_add_u32 v43, v3, 9, s42
    v_mov_b32 v160, s52
    v_mov_b32 v161, s53
    v_mov_b32 v162, s54
    v_mov_b32 v163, s55
    v_lshrrev_b32 v12, 2, v4
    v_lshlrev_b32 v12, 4, v12
    s_lshl_b32 s42, s28, 2
    v_add_u32 v25, s42, v12
    v_lshlrev_b32 v27, 4, v0
    s_lshl_b32 s42, s28, 10
    v_add_u32 v26, s42, v27
    v_lshlrev_b32 v45, 4, v3
    v_lshrrev_b32 v12, 3, v0
    v_lshlrev_b32 v46, 4, v12
    s_mov_b32 s39, 0
W_40:
    ds_read_b32 v5, v1 offset:6800
    s_waitcnt lgkmcnt(0)
    v_readfirstlane_b32 s40, v5
    s_cmp_ge_u32 s40, 1
    s_cbranch_scc1 W_41
    s_sleep 2
    s_add_u32 s39, s39, 1
    s_cmp_lt_u32 s39, 1048576
    s_cbranch_scc1 W_40
    s_branch L_end
W_41:
    ds_read_b128 v[48:51], v16 offset:8192
    ds_read_b128 v[52:55], v17 offset:8192
    ds_read_b128 v[56:59], v18 offset:8192
    ds_read_b128 v[60:63], v19 offset:8192
    ds_read_b128 v[64:67], v16 offset:9216
    ds_read_b128 v[68:71], v17 offset:9216
    ds_read_b128 v[72:75], v18 offset:9216
    ds_read_b128 v[76:79], v19 offset:9216
    s_mov_b32 s39, 0
W_42:
    ds_read_b32 v5, v1 offset:6792
    s_waitcnt lgkmcnt(0)
    v_readfirstlane_b32 s40, v5
    s_cmp_ge_u32 s40, 1
    s_cbranch_scc1 W_43
    s_sleep 1
    s_add_u32 s39, s39, 1
    s_cmp_lt_u32 s39, 1048576
    s_cbranch_scc1 W_42
    s_branch L_end
W_43:
    ds_read_b128 v[80:83], v24 offset:0
    ds_read_b128 v[84:87], v24 offset:64
    ds_read_b128 v[88:91], v24 offset:128
    ds_read_b128 v[92:95], v24 offset:192
    ds_read_b32 v5, v1 offset:6796
    s_waitcnt lgkmcnt(0)
    v_readfirstlane_b32 s33, v5
    s_min_u32 s33, s33, 1
    s_mul_i32 s40, s33, 4194304
    s_add_u32 s34, s24, s40
    s_addc_u32 s35, s25, 0
    v_mfma_f32_16x16x32_bf16 v[112:115], v[48:51], v[80:83], 0
    v_mfma_f32_16x16x32_bf16 v[116:119], v[64:67], v[80:83], 0
    v_mfma_f32_16x16x32_bf16 v[112:115], v[52:55], v[84:87], v[112:115]
    v_mfma_f32_16x16x32_bf16 v[116:119], v[68:71], v[84:87], v[116:119]
    v_mfma_f32_16x16x32_bf16 v[112:115], v[56:59], v[88:91], v[112:115]
    v_mfma_f32_16x16x32_bf16 v[116:119], v[72:75], v[88:91], v[116:119]
    v_mfma_f32_16x16x32_bf16 v[112:115], v[60:63], v[92:95], v[112:115]
    v_mfma_f32_16x16x32_bf16 v[116:119], v[76:79], v[92:95], v[116:119]
    s_nop 7
    v_cvt_pk_bf16_f32 v5, v112, v113
    v_cvt_pk_bf16_f32 v6, v114, v115
    v_cvt_pk_bf16_f32 v7, v116, v117
    v_cvt_pk_bf16_f32 v8, v118, v119
    v_lshlrev_b32 v112, 16, v5
    v_and_b32 v113, 0xffff0000, v5
    v_lshlrev_b32 v114, 16, v6
    v_and_b32 v115, 0xffff0000, v6
    v_lshlrev_b32 v116, 16, v7
    v_and_b32 v117, 0xffff0000, v7
    v_lshlrev_b32 v118, 16, v8
    v_and_b32 v119, 0xffff0000, v8
    v_mul_f32 v112, 0x3db504f3, v112
    v_mul_f32 v113, 0x3db504f3, v113
    v_mul_f32 v114, 0x3db504f3, v114
    v_mul_f32 v115, 0x3db504f3, v115
    v_mul_f32 v116, 0x3db504f3, v116
    v_mul_f32 v117, 0x3db504f3, v117
    v_mul_f32 v118, 0x3db504f3, v118
    v_mul_f32 v119, 0x3db504f3, v119
    v_cvt_pk_bf16_f32 v5, v112, v113
    v_cvt_pk_bf16_f32 v6, v114, v115
    v_cvt_pk_bf16_f32 v7, v116, v117
    v_cvt_pk_bf16_f32 v8, v118, v119
    v_lshlrev_b32 v112, 16, v5
    v_and_b32 v113, 0xffff0000, v5
    v_lshlrev_b32 v114, 16, v6
    v_and_b32 v115, 0xffff0000, v6
    v_lshlrev_b32 v116, 16, v7
    v_and_b32 v117, 0xffff0000, v7
    v_lshlrev_b32 v118, 16, v8
    v_and_b32 v119, 0xffff0000, v8
    v_max3_f32 v5, v112, v113, v114
    v_max3_f32 v6, v115, v116, v117
    v_max3_f32 v5, v5, v118, v119
    v_max_f32 v44, v5, v6
    v_mov_b32 v5, v44
    s_nop 1
    v_permlane16_swap_b32 v44, v5
    v_max_f32 v44, v44, v5
    v_mov_b32 v5, v44
    s_nop 1
    v_permlane32_swap_b32 v44, v5
    v_max_f32 v44, v44, v5
    v_mov_b32 v13, 0x3fb8aa3b
    v_mul_f32 v14, v44, v13
    s_mov_b64 exec, 0x1111
    ds_write_b32 v25, v44 offset:6144
    s_mov_b64 exec, -1
    v_fma_f32 v112, v112, v13, -v14
    v_fma_f32 v113, v113, v13, -v14
    v_fma_f32 v114, v114, v13, -v14
    v_fma_f32 v115, v115, v13, -v14
    v_fma_f32 v116, v116, v13, -v14
    v_fma_f32 v117, v117, v13, -v14
    v_fma_f32 v118, v118, v13, -v14
    v_fma_f32 v119, v119, v13, -v14
    v_exp_f32 v112, v112
    v_exp_f32 v113, v113
    v_exp_f32 v114, v114
    v_exp_f32 v115, v115
    v_exp_f32 v116, v116
    v_exp_f32 v117, v117
    v_exp_f32 v118, v118
    v_exp_f32 v119, v119
    s_nop 0
    v_cvt_pk_bf16_f32 v6, v112, v113
    v_cvt_pk_bf16_f32 v7, v114, v115
    v_cvt_pk_bf16_f32 v8, v116, v117
    v_cvt_pk_bf16_f32 v9, v118, v119
    ds_write_b128 v26, v[6:9] offset:2048
    s_mov_b64 exec, 1
    ds_add_u32 v1, v2 offset:6808
    s_mov_b64 exec, -1
    s_mov_b32 s39, 0
W_44:
    ds_read_b32 v11, v1 offset:6808
    s_waitcnt lgkmcnt(0)
    v_readfirstlane_b32 s40, v11
    s_cmp_ge_u32 s40, 4
    s_cbranch_scc1 W_45
    s_add_u32 s39, s39, 1
    s_cmp_lt_u32 s39, 1048576
    s_cbranch_scc1 W_44
    s_branch L_end
W_45:
    ds_read_b128 v[48:51], v27 offset:2048
    ds_read_b128 v[52:55], v27 offset:3072
    ds_read_b128 v[56:59], v27 offset:4096
    ds_read_b128 v[60:63], v27 offset:5120
    ds_read_b128 v[120:123], v45 offset:6144
    s_waitcnt lgkmcnt(0)
    v_max3_f32 v44, v120, v121, v122
    v_max_f32 v44, v44, v123
    v_mul_f32 v14, v44, v13
    v_fma_f32 v120, v120, v13, -v14
    v_fma_f32 v121, v121, v13, -v14
    v_fma_f32 v122, v122, v13, -v14
    v_fma_f32 v123, v123, v13, -v14
    v_exp_f32 v120, v120
    v_exp_f32 v121, v121
    v_exp_f32 v122, v122
    v_exp_f32 v123, v123
    s_cmp_lg_u32 s28, 0
    s_cbranch_scc1 NS_46
    v_mov_b32 v64, 0x3f803f80
    v_mov_b32 v65, 0x3f803f80
    v_mov_b32 v66, 0x3f803f80
    v_mov_b32 v67, 0x3f803f80
    s_nop 1
    v_mfma_f32_16x16x32_bf16 v[128:131], v[48:51], v[64:67], 0
    v_mfma_f32_16x16x32_bf16 v[132:135], v[52:55], v[64:67], 0
    v_mfma_f32_16x16x32_bf16 v[136:139], v[56:59], v[64:67], 0
    v_mfma_f32_16x16x32_bf16 v[140:143], v[60:63], v[64:67], 0
    v_mov_b32 v124, v44
    v_mov_b32 v126, v38
    v_mov_b32 v127, v39
    s_nop 4
    v_mul_f32 v125, v120, v128
    v_fmac_f32 v125, v121, v132
    v_fmac_f32 v125, v122, v136
    v_fmac_f32 v125, v123, v140
NS_46:
    s_mov_b32 s44, 0
    s_mov_b32 s45, 0
    s_cmp_ge_u32 s44, 1
    s_cbranch_scc1 V_47
    s_mov_b32 s39, 0
V_48:
    ds_read_b64 v[6:7], v1 offset:6784
    s_add_u32 s39, s39, 1
    s_cmp_gt_u32 s39, 1048576
    s_cbranch_scc1 L_end
    s_waitcnt lgkmcnt(0)
    v_readfirstlane_b32 s44, v6
    v_readfirstlane_b32 s45, v7
    s_cmp_lt_u32 s44, 1
    s_cbranch_scc1 V_48
V_47:
    ds_read_b64_tr_b16 v[64:65], v20 offset:0
    ds_read_b64_tr_b16 v[66:67], v20 offset:1024
    ds_read_b64_tr_b16 v[68:69], v21 offset:0
    ds_read_b64_tr_b16 v[70:71], v21 offset:1024
    s_cmp_ge_u32 s44, 2
    s_cbranch_scc1 V_49
    s_mov_b32 s39, 0
V_50:
    ds_read_b64 v[6:7], v1 offset:6784
    s_add_u32 s39, s39, 1
    s_cmp_gt_u32 s39, 1048576
    s_cbranch_scc1 L_end
    s_waitcnt lgkmcnt(0)
    v_readfirstlane_b32 s44, v6
    v_readfirstlane_b32 s45, v7
    s_cmp_lt_u32 s44, 2
    s_cbranch_scc1 V_50
V_49:
    ds_read_b64_tr_b16 v[72:73], v20 offset:8192
    ds_read_b64_tr_b16 v[74:75], v20 offset:9216
    ds_read_b64_tr_b16 v[76:77], v21 offset:8192
    ds_read_b64_tr_b16 v[78:79], v21 offset:9216
    s_waitcnt lgkmcnt(4)
    v_mfma_f32_16x16x32_bf16 v[128:131], v[48:51], v[64:67], 0
    v_mfma_f32_16x16x32_bf16 v[132:135], v[48:51], v[68:71], 0
    s_cmp_ge_u32 s44, 3
    s_cbranch_scc1 V_51
    s_mov_b32 s39, 0
V_52:
    ds_read_b64 v[6:7], v1 offset:6784
    s_add_u32 s39, s39, 1
    s_cmp_gt_u32 s39, 1048576
    s_cbranch_scc1 L_end
    s_waitcnt lgkmcnt(0)
    v_readfirstlane_b32 s44, v6
    v_readfirstlane_b32 s45, v7
    s_cmp_lt_u32 s44, 3
    s_cbranch_scc1 V_52
V_51:
    ds_read_b64_tr_b16 v[80:81], v20 offset:16384
    ds_read_b64_tr_b16 v[82:83], v20 offset:17408
    ds_read_b64_tr_b16 v[84:85], v21 offset:16384
    ds_read_b64_tr_b16 v[86:87], v21 offset:17408
    s_waitcnt lgkmcnt(4)
    v_mfma_f32_16x16x32_bf16 v[136:139], v[52:55], v[72:75], 0
    v_mfma_f32_16x16x32_bf16 v[140:143], v[52:55], v[76:79], 0
    s_cmp_ge_u32 s44, 4
    s_cbranch_scc1 V_53
    s_mov_b32 s39, 0
V_54:
    ds_read_b64 v[6:7], v1 offset:6784
    s_add_u32 s39, s39, 1
    s_cmp_gt_u32 s39, 1048576
    s_cbranch_scc1 L_end
    s_waitcnt lgkmcnt(0)
    v_readfirstlane_b32 s44, v6
    v_readfirstlane_b32 s45, v7
    s_cmp_lt_u32 s44, 4
    s_cbranch_scc1 V_54
V_53:
    ds_read_b64_tr_b16 v[88:89], v20 offset:24576
    ds_read_b64_tr_b16 v[90:91], v20 offset:25600
    ds_read_b64_tr_b16 v[92:93], v21 offset:24576
    ds_read_b64_tr_b16 v[94:95], v21 offset:25600
    s_waitcnt lgkmcnt(4)
    v_mfma_f32_16x16x32_bf16 v[144:147], v[56:59], v[80:83], 0
    v_mfma_f32_16x16x32_bf16 v[148:151], v[56:59], v[84:87], 0
    s_waitcnt lgkmcnt(2)
    v_mfma_f32_16x16x32_bf16 v[152:155], v[60:63], v[88:91], 0
    s_waitcnt lgkmcnt(0)
    v_mfma_f32_16x16x32_bf16 v[156:159], v[60:63], v[92:95], 0
    v_mul_f32 v36, v120, v128
    v_mul_f32 v37, v120, v132
    v_fmac_f32 v36, v121, v136
    v_fmac_f32 v37, v121, v140
    v_fmac_f32 v36, v122, v144
    v_fmac_f32 v37, v122, v148
    s_nop 1
    v_fmac_f32 v36, v123, v152
    v_fmac_f32 v37, v123, v156
    v_and_or_b32 v164, v36, s57, v160
    v_and_or_b32 v165, v37, s57, v161
    v_mov_b32_dpp v166, v36 quad_perm:[1,1,3,3] row_mask:0xf bank_mask:0xf
    v_mov_b32_dpp v167, v37 quad_perm:[1,1,3,3] row_mask:0xf bank_mask:0xf
    v_and_or_b32 v166, v166, s57, v162
    v_and_or_b32 v167, v167, s57, v163
    s_mov_b32 exec_lo, 0x55555555
    s_mov_b32 exec_hi, 0x55555555
    s_cmp_lg_u32 s33, 0
    s_cbranch_scc1 S_55
    global_store_dwordx4 v40, v[164:167], s[34:35]
    s_branch S_56
S_55:
    global_store_dwordx4 v40, v[164:167], s[34:35] sc1
S_56:
    s_mov_b64 exec, -1
    s_cmp_lg_u32 s28, 0
    s_cbranch_scc1 NS_57
    s_mov_b32 s42, 0x00010001
    s_mov_b32 s43, 0x00010001
    s_mov_b64 exec, s[42:43]
    s_cmp_lg_u32 s33, 0
    s_cbranch_scc1 S_58
    global_store_dwordx4 v43, v[124:127], s[34:35]
    s_branch S_59
S_58:
    global_store_dwordx4 v43, v[124:127], s[34:35] sc1
S_59:
    s_mov_b64 exec, -1
NS_57:
    s_mov_b64 exec, 1
    ds_add_u32 v1, v2 offset:6820
    s_mov_b64 exec, -1
    s_mov_b32 s39, 0
W_60:
    ds_read_b32 v5, v1 offset:6836
    s_waitcnt lgkmcnt(0)
    v_readfirstlane_b32 s40, v5
    s_cmp_ge_u32 s40, 1
    s_cbranch_scc1 W_61
    s_add_u32 s39, s39, 1
    s_cmp_lt_u32 s39, 1048576
    s_cbranch_scc1 W_60
    s_branch L_end
W_61:
    ds_read_b128 v[96:99], v22 offset:0
    ds_read_b128 v[100:103], v22 offset:1024
    ds_read_b128 v[104:107], v22 offset:2048
    ds_read_b128 v[108:111], v22 offset:3072
    s_mov_b32 s39, 0
O_62:
    ds_read_b128 v[8:11], v46 offset:6848
    s_add_u32 s39, s39, 1
    s_cmp_gt_u32 s39, 1048576
    s_cbranch_scc1 L_end
    s_waitcnt lgkmcnt(0)
    v_and_b32 v9, v9, v11
    v_cmp_ne_u32 vcc, 1, v9
    s_cbranch_vccnz O_62
    v_perm_b32 v64, v8, v8, v28
    v_perm_b32 v65, v8, v8, v29
    v_perm_b32 v66, v8, v8, v30
    v_perm_b32 v67, v8, v8, v31
    v_perm_b32 v68, v8, v8, v32
    v_perm_b32 v69, v8, v8, v33
    v_perm_b32 v70, v8, v8, v34
    v_perm_b32 v71, v8, v8, v35
    v_mfma_f32_16x16x32_bf16 v[112:115], v[64:67], v[96:99], 0
    v_perm_b32 v72, v10, v10, v28
    v_perm_b32 v73, v10, v10, v29
    v_perm_b32 v74, v10, v10, v30
    v_perm_b32 v75, v10, v10, v31
    v_mfma_f32_16x16x32_bf16 v[112:115], v[68:71], v[100:103], v[112:115]
    v_perm_b32 v76, v10, v10, v32
    v_perm_b32 v77, v10, v10, v33
    v_perm_b32 v78, v10, v10, v34
    v_perm_b32 v79, v10, v10, v35
    v_mfma_f32_16x16x32_bf16 v[112:115], v[72:75], v[104:107], v[112:115]
    s_nop 1
    v_mfma_f32_16x16x32_bf16 v[112:115], v[76:79], v[108:111], v[112:115]
    s_nop 7
    v_permlane32_swap_b32 v112, v114
    v_permlane32_swap_b32 v113, v115
    s_mov_b32 s42, 0x00ff00ff
    s_mov_b32 s43, 0
    v_add_f32_dpp v112, v114, v112 row_ror:8 row_mask:0xf bank_mask:0xf
    v_add_f32_dpp v113, v115, v113 row_ror:8 row_mask:0xf bank_mask:0xf
    s_nop 1
    v_permlane32_swap_b32 v112, v114
    v_permlane32_swap_b32 v113, v115
    v_and_or_b32 v164, v112, s57, v160
    v_and_or_b32 v165, v113, s57, v161
    v_and_or_b32 v166, v114, s57, v162
    v_and_or_b32 v167, v115, s57, v163
    s_mov_b64 exec, s[42:43]
    s_cmp_lg_u32 s33, 0
    s_cbranch_scc1 S_63
    global_store_dwordx4 v41, v[164:167], s[34:35]
    s_branch S_64
S_63:
    global_store_dwordx4 v41, v[164:167], s[34:35] sc1
S_64:
    s_mov_b64 exec, -1
    s_mov_b64 exec, 1
    ds_add_u32 v1, v2 offset:6832
    s_mov_b64 exec, -1
    s_endpgm
.p2align 8
L_L:
    v_mov_b32 v1, 0
    v_mov_b32 v2, 1
    s_lshl_b32 s40, s26, 24
    s_add_u32 s40, s40, 0xF00000
    s_lshl_b32 s41, s27, 10
    s_add_u32 s40, s40, s41
    v_lshrrev_b32 v3, 4, v0
    v_and_b32 v4, 15, v0
    v_xor_b32 v5, v4, v3
    v_lshl_add_u32 v6, v3, 8, s40
    v_xor_b32 v7, 0, v5
    v_lshl_add_u32 v7, v7, 4, v6
    v_add_u32 v8, 0, v7
    v_xor_b32 v7, 4, v5
    v_lshl_add_u32 v7, v7, 4, v6
    v_add_u32 v9, 65536, v7
    v_xor_b32 v7, 8, v5
    v_lshl_add_u32 v7, v7, 4, v6
    v_add_u32 v10, 131072, v7
    v_xor_b32 v7, 12, v5
    v_lshl_add_u32 v7, v7, 4, v6
    v_add_u32 v11, 196608, v7
    s_waitcnt lgkmcnt(0)
    s_load_dwordx2 s[30:31], s[24:25], 0
    s_barrier
    s_setprio 2
    s_cmp_lt_u32 s26, 4
    s_cselect_b32 s49, 32, 24
    s_cmp_lt_u32 s27, s49
    s_cselect_b32 s38, 1, 0
    s_mul_i32 s50, s26, 4
    s_sub_u32 s51, s26, 4
    s_mul_i32 s51, s51, 3
    s_add_u32 s51, s51, 16
    s_cmp_lt_u32 s26, 4
    s_cselect_b32 s50, s50, s51
    s_lshr_b32 s51, s27, 3
    s_add_u32 s50, s50, s51
    v_lshlrev_b32 v7, 1, v3
    v_xor_b32 v7, v7, v4
    v_lshl_add_u32 v12, v7, 4, v6
    v_xor_b32 v7, 8, v7
    v_lshl_add_u32 v7, v7, 4, v6
    v_add_u32 v13, 65536, v7
    s_lshl_b32 s42, s26, 9
    s_lshr_b32 s43, s27, 3
    s_lshl_b32 s43, s43, 7
    s_add_u32 s42, s42, s43
    s_bfe_u32 s43, s27, 0x20001
    s_lshl_b32 s43, s43, 5
    s_add_u32 s42, s42, s43
    s_lshl_b32 s42, s42, 10
    s_and_b32 s43, s27, 1
    s_lshl_b32 s43, s43, 9
    s_add_u32 s42, s42, s43
    v_lshrrev_b32 v6, 3, v0
    v_lshlrev_b32 v6, 11, v6
    v_and_b32 v7, 7, v0
    v_lshl_add_u32 v7, v7, 4, v6
    v_add_u32 v16, s42, v7
    v_add_u32 v17, 0x4000, v16
    s_lshl_b32 s42, s50, 16
    s_and_b32 s43, s27, 7
    s_lshl_b32 s43, s43, 7
    s_add_u32 s42, s42, s43
    v_lshrrev_b32 v6, 3, v0
    v_lshlrev_b32 v6, 13, v6
    v_and_b32 v7, 7, v0
    v_lshl_add_u32 v6, v7, 4, v6
    v_add_u32 v18, s42, v6
    v_add_u32 v19, 0x1000, v18
    s_mov_b32 s39, 0
W_65:
    ds_read_b32 v21, v1 offset:6812
    s_waitcnt lgkmcnt(0)
    v_readfirstlane_b32 s40, v21
    s_cmp_ge_u32 s40, 1
    s_cbranch_scc1 W_66
    s_add_u32 s39, s39, 1
    s_cmp_lt_u32 s39, 1048576
    s_cbranch_scc1 W_65
    s_branch L_end
W_66:
    s_cmp_lg_u32 s38, 0
    s_cbranch_scc1 LB_67
    s_movk_i32 m0, 0x2000
    s_nop 0
    global_load_lds_dwordx4 v8, s[6:7] nt
    v_add_u32 v8, 0x8000, v8
    s_movk_i32 m0, 0x2400
    s_nop 0
    global_load_lds_dwordx4 v8, s[6:7] nt
    v_add_u32 v8, 0x38000, v8
    s_movk_i32 m0, 0x2800
    s_nop 0
    global_load_lds_dwordx4 v9, s[6:7] nt
    v_add_u32 v9, 0x8000, v9
    s_movk_i32 m0, 0x2c00
    s_nop 0
    global_load_lds_dwordx4 v9, s[6:7] nt
    v_add_u32 v9, 0x38000, v9
    s_movk_i32 m0, 0x3000
    s_nop 0
    global_load_lds_dwordx4 v10, s[6:7] nt
    v_add_u32 v10, 0x8000, v10
    s_movk_i32 m0, 0x3400
    s_nop 0
    global_load_lds_dwordx4 v10, s[6:7] nt
    v_add_u32 v10, 0x38000, v10
    s_movk_i32 m0, 0x3800
    s_nop 0
    global_load_lds_dwordx4 v11, s[6:7] nt
    v_add_u32 v11, 0x8000, v11
    s_movk_i32 m0, 0x3c00
    s_nop 0
    global_load_lds_dwordx4 v11, s[6:7] nt
    v_add_u32 v11, 0x38000, v11
    s_movk_i32 m0, 0x4000
    s_nop 0
    global_load_lds_dwordx4 v8, s[6:7] nt
    v_add_u32 v8, 0x8000, v8
    s_movk_i32 m0, 0x4400
    s_nop 0
    global_load_lds_dwordx4 v8, s[6:7] nt
    v_add_u32 v8, 0x38000, v8
    s_movk_i32 m0, 0x4800
    s_nop 0
    global_load_lds_dwordx4 v9, s[6:7] nt
    v_add_u32 v9, 0x8000, v9
    s_movk_i32 m0, 0x4c00
    s_nop 0
    global_load_lds_dwordx4 v9, s[6:7] nt
    v_add_u32 v9, 0x38000, v9
    s_movk_i32 m0, 0x5000
    s_nop 0
    global_load_lds_dwordx4 v10, s[6:7] nt
    v_add_u32 v10, 0x8000, v10
    s_movk_i32 m0, 0x5400
    s_nop 0
    global_load_lds_dwordx4 v10, s[6:7] nt
    v_add_u32 v10, 0x38000, v10
    s_movk_i32 m0, 0x5800
    s_nop 0
    global_load_lds_dwordx4 v11, s[6:7] nt
    v_add_u32 v11, 0x8000, v11
    s_movk_i32 m0, 0x5c00
    s_nop 0
    global_load_lds_dwordx4 v11, s[6:7] nt
    v_add_u32 v11, 0x38000, v11
    ds_read_b32 v21, v1 offset:6792
    s_waitcnt vmcnt(15)
    s_waitcnt lgkmcnt(0)
    v_readfirstlane_b32 s40, v21
    s_cmp_lg_u32 s40, 0
    s_cbranch_scc1 FAST_68
    s_movk_i32 m0, 0x6000
    s_nop 0
    global_load_lds_dwordx4 v8, s[6:7] nt
    v_add_u32 v8, 0x8000, v8
    s_waitcnt vmcnt(15)
    s_movk_i32 m0, 0x6400
    s_nop 0
    global_load_lds_dwordx4 v8, s[6:7] nt
    v_add_u32 v8, 0x38000, v8
    s_waitcnt vmcnt(15)
    s_movk_i32 m0, 0x6800
    s_nop 0
    global_load_lds_dwordx4 v9, s[6:7] nt
    v_add_u32 v9, 0x8000, v9
    s_waitcnt vmcnt(15)
    s_movk_i32 m0, 0x6c00
    s_nop 0
    global_load_lds_dwordx4 v9, s[6:7] nt
    v_add_u32 v9, 0x38000, v9
    ds_read_b32 v21, v1 offset:6792
    s_waitcnt vmcnt(15)
    s_waitcnt lgkmcnt(0)
    v_readfirstlane_b32 s40, v21
    s_cmp_lg_u32 s40, 0
    s_cbranch_scc1 FAST_69
    s_movk_i32 m0, 0x7000
    s_nop 0
    global_load_lds_dwordx4 v10, s[6:7] nt
    v_add_u32 v10, 0x8000, v10
    s_waitcnt vmcnt(15)
    s_movk_i32 m0, 0x7400
    s_nop 0
    global_load_lds_dwordx4 v10, s[6:7] nt
    v_add_u32 v10, 0x38000, v10
    s_waitcnt vmcnt(15)
    s_movk_i32 m0, 0x7800
    s_nop 0
    global_load_lds_dwordx4 v11, s[6:7] nt
    v_add_u32 v11, 0x8000, v11
    s_waitcnt vmcnt(15)
    s_movk_i32 m0, 0x7c00
    s_nop 0
    global_load_lds_dwordx4 v11, s[6:7] nt
    v_add_u32 v11, 0x38000, v11
    ds_read_b32 v21, v1 offset:6792
    s_waitcnt vmcnt(15)
    s_waitcnt lgkmcnt(0)
    v_readfirstlane_b32 s40, v21
    s_cmp_lg_u32 s40, 0
    s_cbranch_scc1 FAST_70
    s_mov_b32 m0, 0x8000
    s_nop 0
    global_load_lds_dwordx4 v8, s[6:7] nt
    v_add_u32 v8, 0x8000, v8
    s_waitcnt vmcnt(15)
    s_mov_b32 m0, 0x8400
    s_nop 0
    global_load_lds_dwordx4 v8, s[6:7] nt
    v_add_u32 v8, 0x38000, v8
    s_waitcnt vmcnt(15)
    s_mov_b32 m0, 0x8800
    s_nop 0
    global_load_lds_dwordx4 v9, s[6:7] nt
    v_add_u32 v9, 0x8000, v9
    s_waitcnt vmcnt(15)
    s_mov_b32 m0, 0x8c00
    s_nop 0
    global_load_lds_dwordx4 v9, s[6:7] nt
    v_add_u32 v9, 0x38000, v9
    ds_read_b32 v21, v1 offset:6792
    s_waitcnt vmcnt(15)
    s_waitcnt lgkmcnt(0)
    v_readfirstlane_b32 s40, v21
    s_cmp_lg_u32 s40, 0
    s_cbranch_scc1 FAST_71
    s_mov_b32 m0, 0x9000
    s_nop 0
    global_load_lds_dwordx4 v10, s[6:7] nt
    v_add_u32 v10, 0x8000, v10
    s_waitcnt vmcnt(15)
    s_mov_b32 m0, 0x9400
    s_nop 0
    global_load_lds_dwordx4 v10, s[6:7] nt
    v_add_u32 v10, 0x38000, v10
    s_waitcnt vmcnt(15)
    s_mov_b32 m0, 0x9800
    s_nop 0
    global_load_lds_dwordx4 v11, s[6:7] nt
    v_add_u32 v11, 0x8000, v11
    s_waitcnt vmcnt(15)
    s_mov_b32 m0, 0x9c00
    s_nop 0
    global_load_lds_dwordx4 v11, s[6:7] nt
    v_add_u32 v11, 0x38000, v11
    ds_read_b32 v21, v1 offset:6792
    s_waitcnt vmcnt(15)
    s_waitcnt lgkmcnt(0)
    v_readfirstlane_b32 s40, v21
    s_cmp_lg_u32 s40, 0
    s_cbranch_scc1 FAST_72
    s_mov_b32 m0, 0xa000
    s_nop 0
    global_load_lds_dwordx4 v12, s[8:9] nt
    v_add_u32 v12, 0x8000, v12
    s_waitcnt vmcnt(15)
    s_mov_b32 m0, 0xa400
    s_nop 0
    global_load_lds_dwordx4 v12, s[8:9] nt
    v_add_u32 v12, 0x18000, v12
    s_waitcnt vmcnt(15)
    s_mov_b32 m0, 0xa800
    s_nop 0
    global_load_lds_dwordx4 v13, s[8:9] nt
    v_add_u32 v13, 0x8000, v13
    s_waitcnt vmcnt(15)
    s_mov_b32 m0, 0xac00
    s_nop 0
    global_load_lds_dwordx4 v13, s[8:9] nt
    v_add_u32 v13, 0x18000, v13
    ds_read_b32 v21, v1 offset:6792
    s_waitcnt vmcnt(15)
    s_waitcnt lgkmcnt(0)
    v_readfirstlane_b32 s40, v21
    s_cmp_lg_u32 s40, 0
    s_cbranch_scc1 FAST_73
    s_mov_b32 m0, 0xb000
    s_nop 0
    global_load_lds_dwordx4 v12, s[8:9] nt
    v_add_u32 v12, 0x8000, v12
    s_waitcnt vmcnt(15)
    s_mov_b32 m0, 0xb400
    s_nop 0
    global_load_lds_dwordx4 v12, s[8:9] nt
    v_add_u32 v12, 0x18000, v12
    s_waitcnt vmcnt(15)
    s_mov_b32 m0, 0xb800
    s_nop 0
    global_load_lds_dwordx4 v13, s[8:9] nt
    v_add_u32 v13, 0x8000, v13
    s_waitcnt vmcnt(15)
    s_mov_b32 m0, 0xbc00
    s_nop 0
    global_load_lds_dwordx4 v13, s[8:9] nt
    v_add_u32 v13, 0x18000, v13
    ds_read_b32 v21, v1 offset:6792
    s_waitcnt vmcnt(15)
    s_waitcnt lgkmcnt(0)
    v_readfirstlane_b32 s40, v21
    s_cmp_lg_u32 s40, 0
    s_cbranch_scc1 FAST_74
    s_mov_b32 m0, 0xc000
    s_nop 0
    global_load_lds_dwordx4 v12, s[8:9] nt
    v_add_u32 v12, 0x8000, v12
    s_waitcnt vmcnt(15)
    s_mov_b32 m0, 0xc400
    s_nop 0
    global_load_lds_dwordx4 v12, s[8:9] nt
    v_add_u32 v12, 0x18000, v12
    s_waitcnt vmcnt(15)
    s_mov_b32 m0, 0xc800
    s_nop 0
    global_load_lds_dwordx4 v13, s[8:9] nt
    v_add_u32 v13, 0x8000, v13
    s_waitcnt vmcnt(15)
    s_mov_b32 m0, 0xcc00
    s_nop 0
    global_load_lds_dwordx4 v13, s[8:9] nt
    v_add_u32 v13, 0x18000, v13
    ds_read_b32 v21, v1 offset:6792
    s_waitcnt vmcnt(15)
    s_waitcnt lgkmcnt(0)
    v_readfirstlane_b32 s40, v21
    s_cmp_lg_u32 s40, 0
    s_cbranch_scc1 FAST_75
    s_mov_b32 m0, 0xd000
    s_nop 0
    global_load_lds_dwordx4 v12, s[8:9] nt
    v_add_u32 v12, 0x8000, v12
    s_waitcnt vmcnt(15)
    s_mov_b32 m0, 0xd400
    s_nop 0
    global_load_lds_dwordx4 v12, s[8:9] nt
    v_add_u32 v12, 0x18000, v12
    s_waitcnt vmcnt(15)
    s_mov_b32 m0, 0xd800
    s_nop 0
    global_load_lds_dwordx4 v13, s[8:9] nt
    v_add_u32 v13, 0x8000, v13
    s_waitcnt vmcnt(15)
    v_mov_b32 v22, 1
    s_mov_b64 exec, 1
    ds_write_b32 v1, v22 offset:6800
    s_mov_b64 exec, -1
    s_mov_b32 m0, 0xdc00
    s_nop 0
    global_load_lds_dwordx4 v13, s[8:9] nt
    v_add_u32 v13, 0x18000, v13
    ds_read_b32 v21, v1 offset:6792
    s_waitcnt vmcnt(15)
    s_waitcnt lgkmcnt(0)
    v_readfirstlane_b32 s40, v21
    s_cmp_lg_u32 s40, 0
    s_cbranch_scc1 FAST_76
    s_mov_b32 m0, 0xe000
    s_nop 0
    global_load_lds_dwordx4 v12, s[8:9] nt
    v_add_u32 v12, 0x8000, v12
    s_waitcnt vmcnt(15)
    s_mov_b32 m0, 0xe400
    s_nop 0
    global_load_lds_dwordx4 v12, s[8:9] nt
    v_add_u32 v12, 0x18000, v12
    s_waitcnt vmcnt(15)
    s_mov_b32 m0, 0xe800
    s_nop 0
    global_load_lds_dwordx4 v13, s[8:9] nt
    v_add_u32 v13, 0x8000, v13
    s_waitcnt vmcnt(15)
    s_mov_b32 m0, 0xec00
    s_nop 0
    global_load_lds_dwordx4 v13, s[8:9] nt
    v_add_u32 v13, 0x18000, v13
    ds_read_b32 v21, v1 offset:6792
    s_waitcnt vmcnt(15)
    s_waitcnt lgkmcnt(0)
    v_readfirstlane_b32 s40, v21
    s_cmp_lg_u32 s40, 0
    s_cbranch_scc1 FAST_77
    s_mov_b32 m0, 0xf000
    s_nop 0
    global_load_lds_dwordx4 v12, s[8:9] nt
    v_add_u32 v12, 0x8000, v12
    s_waitcnt vmcnt(15)
    s_mov_b32 m0, 0xf400
    s_nop 0
    global_load_lds_dwordx4 v12, s[8:9] nt
    v_add_u32 v12, 0x18000, v12
    s_waitcnt vmcnt(15)
    s_mov_b32 m0, 0xf800
    s_nop 0
    global_load_lds_dwordx4 v13, s[8:9] nt
    v_add_u32 v13, 0x8000, v13
    s_waitcnt vmcnt(15)
    v_mov_b32 v22, 1
    s_mov_b64 exec, 1
    ds_write_b32 v1, v22 offset:6784
    s_mov_b64 exec, -1
    s_mov_b32 m0, 0xfc00
    s_nop 0
    global_load_lds_dwordx4 v13, s[8:9] nt
    v_add_u32 v13, 0x18000, v13
    ds_read_b32 v21, v1 offset:6792
    s_waitcnt vmcnt(15)
    s_waitcnt lgkmcnt(0)
    v_readfirstlane_b32 s40, v21
    s_cmp_lg_u32 s40, 0
    s_cbranch_scc1 FAST_78
    s_mov_b32 m0, 0x10000
    s_nop 0
    global_load_lds_dwordx4 v12, s[8:9] nt
    v_add_u32 v12, 0x8000, v12
    s_waitcnt vmcnt(15)
    s_mov_b32 m0, 0x10400
    s_nop 0
    global_load_lds_dwordx4 v12, s[8:9] nt
    v_add_u32 v12, 0x18000, v12
    s_waitcnt vmcnt(15)
    s_mov_b32 m0, 0x10800
    s_nop 0
    global_load_lds_dwordx4 v13, s[8:9] nt
    v_add_u32 v13, 0x8000, v13
    s_waitcnt vmcnt(15)
    s_mov_b32 m0, 0x10c00
    s_nop 0
    global_load_lds_dwordx4 v13, s[8:9] nt
    v_add_u32 v13, 0x18000, v13
    ds_read_b32 v21, v1 offset:6792
    s_waitcnt vmcnt(15)
    s_waitcnt lgkmcnt(0)
    v_readfirstlane_b32 s40, v21
    s_cmp_lg_u32 s40, 0
    s_cbranch_scc1 FAST_79
    s_mov_b32 m0, 0x11000
    s_nop 0
    global_load_lds_dwordx4 v12, s[8:9] nt
    v_add_u32 v12, 0x8000, v12
    s_waitcnt vmcnt(15)
    s_mov_b32 m0, 0x11400
    s_nop 0
    global_load_lds_dwordx4 v12, s[8:9] nt
    v_add_u32 v12, 0x18000, v12
    s_waitcnt vmcnt(15)
    s_mov_b32 m0, 0x11800
    s_nop 0
    global_load_lds_dwordx4 v13, s[8:9] nt
    v_add_u32 v13, 0x8000, v13
    s_waitcnt vmcnt(15)
    v_mov_b32 v22, 2
    s_mov_b64 exec, 1
    ds_write_b32 v1, v22 offset:6784
    s_mov_b64 exec, -1
    s_mov_b32 m0, 0x11c00
    s_nop 0
    global_load_lds_dwordx4 v13, s[8:9] nt
    v_add_u32 v13, 0x18000, v13
    s_waitcnt vmcnt(8)
    v_mov_b32 v22, 3
    s_mov_b64 exec, 1
    ds_write_b32 v1, v22 offset:6784
    s_mov_b64 exec, -1
    s_waitcnt vmcnt(0)
    v_mov_b32 v22, 4
    s_mov_b64 exec, 1
    ds_write_b32 v1, v22 offset:6784
    s_mov_b64 exec, -1
    s_mov_b32 s39, 0
W_82:
    ds_read_b32 v21, v1 offset:6820
    s_waitcnt lgkmcnt(0)
    v_readfirstlane_b32 s40, v21
    s_cmp_ge_u32 s40, 4
    s_cbranch_scc1 W_83
    s_add_u32 s39, s39, 1
    s_cmp_lt_u32 s39, 1048576
    s_cbranch_scc1 W_82
    s_branch L_end
W_83:
    ds_read_b32 v21, v1 offset:6792
    s_waitcnt lgkmcnt(0)
    v_readfirstlane_b32 s40, v21
    s_cmp_lg_u32 s40, 0
    s_cbranch_scc1 FAST_80
    s_mov_b32 m0, 0x12000
    s_nop 0
    global_load_lds_dwordx4 v16, s[12:13] offset:0 nt
    s_mov_b32 m0, 0x12400
    s_nop 0
    global_load_lds_dwordx4 v17, s[12:13] offset:0 nt
    s_mov_b32 m0, 0x12400
    s_nop 0
    global_load_lds_dwordx4 v16, s[12:13] offset:1024 nt
    s_mov_b32 m0, 0x12800
    s_nop 0
    global_load_lds_dwordx4 v17, s[12:13] offset:1024 nt
    ds_read_b32 v21, v1 offset:6792
    s_waitcnt lgkmcnt(0)
    v_readfirstlane_b32 s40, v21
    s_cmp_lg_u32 s40, 0
    s_cbranch_scc1 FAST_81
    s_mov_b32 m0, 0x12f80
    s_nop 0
    global_load_lds_dwordx4 v16, s[12:13] offset:128 nt
    s_mov_b32 m0, 0x13380
    s_nop 0
    global_load_lds_dwordx4 v17, s[12:13] offset:128 nt
    s_mov_b32 m0, 0x13380
    s_nop 0
    global_load_lds_dwordx4 v16, s[12:13] offset:1152 nt
    s_mov_b32 m0, 0x13780
    s_nop 0
    global_load_lds_dwordx4 v17, s[12:13] offset:1152 nt
    s_mov_b32 m0, 0x13f00
    s_nop 0
    global_load_lds_dwordx4 v16, s[12:13] offset:256 nt
    s_mov_b32 m0, 0x14300
    s_nop 0
    global_load_lds_dwordx4 v17, s[12:13] offset:256 nt
    s_mov_b32 m0, 0x14300
    s_nop 0
    global_load_lds_dwordx4 v16, s[12:13] offset:1280 nt
    s_mov_b32 m0, 0x14700
    s_nop 0
    global_load_lds_dwordx4 v17, s[12:13] offset:1280 nt
    s_mov_b32 m0, 0x14e80
    s_nop 0
    global_load_lds_dwordx4 v16, s[12:13] offset:384 nt
    s_mov_b32 m0, 0x15280
    s_nop 0
    global_load_lds_dwordx4 v17, s[12:13] offset:384 nt
    s_mov_b32 m0, 0x15280
    s_nop 0
    global_load_lds_dwordx4 v16, s[12:13] offset:1408 nt
    s_mov_b32 m0, 0x15680
    s_nop 0
    global_load_lds_dwordx4 v17, s[12:13] offset:1408 nt
    s_waitcnt vmcnt(0)
    v_mov_b32 v22, 1
    s_mov_b64 exec, 1
    ds_write_b32 v1, v22 offset:6836
    s_mov_b64 exec, -1
    s_endpgm
FAST_68:
    s_movk_i32 m0, 0x6000
    s_nop 0
    global_load_lds_dwordx4 v8, s[6:7] nt
    v_add_u32 v8, 0x8000, v8
    s_movk_i32 m0, 0x6400
    s_nop 0
    global_load_lds_dwordx4 v8, s[6:7] nt
    v_add_u32 v8, 0x38000, v8
    s_movk_i32 m0, 0x6800
    s_nop 0
    global_load_lds_dwordx4 v9, s[6:7] nt
    v_add_u32 v9, 0x8000, v9
    s_movk_i32 m0, 0x6c00
    s_nop 0
    global_load_lds_dwordx4 v9, s[6:7] nt
    v_add_u32 v9, 0x38000, v9
FAST_69:
    s_movk_i32 m0, 0x7000
    s_nop 0
    global_load_lds_dwordx4 v10, s[6:7] nt
    v_add_u32 v10, 0x8000, v10
    s_movk_i32 m0, 0x7400
    s_nop 0
    global_load_lds_dwordx4 v10, s[6:7] nt
    v_add_u32 v10, 0x38000, v10
    s_movk_i32 m0, 0x7800
    s_nop 0
    global_load_lds_dwordx4 v11, s[6:7] nt
    v_add_u32 v11, 0x8000, v11
    s_movk_i32 m0, 0x7c00
    s_nop 0
    global_load_lds_dwordx4 v11, s[6:7] nt
    v_add_u32 v11, 0x38000, v11
FAST_70:
    s_mov_b32 m0, 0x8000
    s_nop 0
    global_load_lds_dwordx4 v8, s[6:7] nt
    v_add_u32 v8, 0x8000, v8
    s_mov_b32 m0, 0x8400
    s_nop 0
    global_load_lds_dwordx4 v8, s[6:7] nt
    v_add_u32 v8, 0x38000, v8
    s_mov_b32 m0, 0x8800
    s_nop 0
    global_load_lds_dwordx4 v9, s[6:7] nt
    v_add_u32 v9, 0x8000, v9
    s_mov_b32 m0, 0x8c00
    s_nop 0
    global_load_lds_dwordx4 v9, s[6:7] nt
    v_add_u32 v9, 0x38000, v9
FAST_71:
    s_mov_b32 m0, 0x9000
    s_nop 0
    global_load_lds_dwordx4 v10, s[6:7] nt
    v_add_u32 v10, 0x8000, v10
    s_mov_b32 m0, 0x9400
    s_nop 0
    global_load_lds_dwordx4 v10, s[6:7] nt
    v_add_u32 v10, 0x38000, v10
    s_mov_b32 m0, 0x9800
    s_nop 0
    global_load_lds_dwordx4 v11, s[6:7] nt
    v_add_u32 v11, 0x8000, v11
    s_mov_b32 m0, 0x9c00
    s_nop 0
    global_load_lds_dwordx4 v11, s[6:7] nt
    v_add_u32 v11, 0x38000, v11
FAST_72:
    s_mov_b32 m0, 0xa000
    s_nop 0
    global_load_lds_dwordx4 v12, s[8:9] nt
    v_add_u32 v12, 0x8000, v12
    s_mov_b32 m0, 0xa400
    s_nop 0
    global_load_lds_dwordx4 v12, s[8:9] nt
    v_add_u32 v12, 0x18000, v12
    s_mov_b32 m0, 0xa800
    s_nop 0
    global_load_lds_dwordx4 v13, s[8:9] nt
    v_add_u32 v13, 0x8000, v13
    s_mov_b32 m0, 0xac00
    s_nop 0
    global_load_lds_dwordx4 v13, s[8:9] nt
    v_add_u32 v13, 0x18000, v13
FAST_73:
    s_mov_b32 m0, 0xb000
    s_nop 0
    global_load_lds_dwordx4 v12, s[8:9] nt
    v_add_u32 v12, 0x8000, v12
    s_mov_b32 m0, 0xb400
    s_nop 0
    global_load_lds_dwordx4 v12, s[8:9] nt
    v_add_u32 v12, 0x18000, v12
    s_mov_b32 m0, 0xb800
    s_nop 0
    global_load_lds_dwordx4 v13, s[8:9] nt
    v_add_u32 v13, 0x8000, v13
    s_mov_b32 m0, 0xbc00
    s_nop 0
    global_load_lds_dwordx4 v13, s[8:9] nt
    v_add_u32 v13, 0x18000, v13
FAST_74:
    s_waitcnt vmcnt(39)
    s_mov_b32 m0, 0xc000
    s_nop 0
    global_load_lds_dwordx4 v12, s[8:9] nt
    v_add_u32 v12, 0x8000, v12
    s_waitcnt vmcnt(39)
    s_mov_b32 m0, 0xc400
    s_nop 0
    global_load_lds_dwordx4 v12, s[8:9] nt
    v_add_u32 v12, 0x18000, v12
    s_waitcnt vmcnt(39)
    s_mov_b32 m0, 0xc800
    s_nop 0
    global_load_lds_dwordx4 v13, s[8:9] nt
    v_add_u32 v13, 0x8000, v13
    s_waitcnt vmcnt(39)
    s_mov_b32 m0, 0xcc00
    s_nop 0
    global_load_lds_dwordx4 v13, s[8:9] nt
    v_add_u32 v13, 0x18000, v13
FAST_75:
    s_waitcnt vmcnt(39)
    s_mov_b32 m0, 0xd000
    s_nop 0
    global_load_lds_dwordx4 v12, s[8:9] nt
    v_add_u32 v12, 0x8000, v12
    s_waitcnt vmcnt(39)
    s_mov_b32 m0, 0xd400
    s_nop 0
    global_load_lds_dwordx4 v12, s[8:9] nt
    v_add_u32 v12, 0x18000, v12
    s_waitcnt vmcnt(39)
    s_mov_b32 m0, 0xd800
    s_nop 0
    global_load_lds_dwordx4 v13, s[8:9] nt
    v_add_u32 v13, 0x8000, v13
    s_waitcnt vmcnt(39)
    s_mov_b32 m0, 0xdc00
    s_nop 0
    global_load_lds_dwordx4 v13, s[8:9] nt
    v_add_u32 v13, 0x18000, v13
FAST_76:
    s_waitcnt vmcnt(39)
    s_mov_b32 m0, 0xe000
    s_nop 0
    global_load_lds_dwordx4 v12, s[8:9] nt
    v_add_u32 v12, 0x8000, v12
    s_waitcnt vmcnt(39)
    s_mov_b32 m0, 0xe400
    s_nop 0
    global_load_lds_dwordx4 v12, s[8:9] nt
    v_add_u32 v12, 0x18000, v12
    s_waitcnt vmcnt(39)
    s_mov_b32 m0, 0xe800
    s_nop 0
    global_load_lds_dwordx4 v13, s[8:9] nt
    v_add_u32 v13, 0x8000, v13
    s_waitcnt vmcnt(39)
    s_mov_b32 m0, 0xec00
    s_nop 0
    global_load_lds_dwordx4 v13, s[8:9] nt
    v_add_u32 v13, 0x18000, v13
FAST_77:
    s_waitcnt vmcnt(39)
    s_mov_b32 m0, 0xf000
    s_nop 0
    global_load_lds_dwordx4 v12, s[8:9] nt
    v_add_u32 v12, 0x8000, v12
    s_waitcnt vmcnt(39)
    s_mov_b32 m0, 0xf400
    s_nop 0
    global_load_lds_dwordx4 v12, s[8:9] nt
    v_add_u32 v12, 0x18000, v12
    s_waitcnt vmcnt(39)
    s_mov_b32 m0, 0xf800
    s_nop 0
    global_load_lds_dwordx4 v13, s[8:9] nt
    v_add_u32 v13, 0x8000, v13
    s_waitcnt vmcnt(39)
    s_mov_b32 m0, 0xfc00
    s_nop 0
    global_load_lds_dwordx4 v13, s[8:9] nt
    v_add_u32 v13, 0x18000, v13
FAST_78:
    s_waitcnt vmcnt(39)
    s_mov_b32 m0, 0x10000
    s_nop 0
    global_load_lds_dwordx4 v12, s[8:9] nt
    v_add_u32 v12, 0x8000, v12
    s_waitcnt vmcnt(39)
    s_mov_b32 m0, 0x10400
    s_nop 0
    global_load_lds_dwordx4 v12, s[8:9] nt
    v_add_u32 v12, 0x18000, v12
    s_waitcnt vmcnt(39)
    s_mov_b32 m0, 0x10800
    s_nop 0
    global_load_lds_dwordx4 v13, s[8:9] nt
    v_add_u32 v13, 0x8000, v13
    s_waitcnt vmcnt(39)
    s_mov_b32 m0, 0x10c00
    s_nop 0
    global_load_lds_dwordx4 v13, s[8:9] nt
    v_add_u32 v13, 0x18000, v13
FAST_79:
    s_waitcnt vmcnt(39)
    s_mov_b32 m0, 0x11000
    s_nop 0
    global_load_lds_dwordx4 v12, s[8:9] nt
    v_add_u32 v12, 0x8000, v12
    s_waitcnt vmcnt(39)
    s_mov_b32 m0, 0x11400
    s_nop 0
    global_load_lds_dwordx4 v12, s[8:9] nt
    v_add_u32 v12, 0x18000, v12
    s_waitcnt vmcnt(39)
    s_mov_b32 m0, 0x11800
    s_nop 0
    global_load_lds_dwordx4 v13, s[8:9] nt
    v_add_u32 v13, 0x8000, v13
    s_waitcnt vmcnt(39)
    s_mov_b32 m0, 0x11c00
    s_nop 0
    global_load_lds_dwordx4 v13, s[8:9] nt
    v_add_u32 v13, 0x18000, v13
FAST_80:
    s_waitcnt vmcnt(32)
    v_mov_b32 v22, 1
    s_mov_b64 exec, 1
    ds_write_b32 v1, v22 offset:6800
    s_mov_b64 exec, -1
    s_waitcnt vmcnt(24)
    v_mov_b32 v22, 1
    s_mov_b64 exec, 1
    ds_write_b32 v1, v22 offset:6784
    s_mov_b64 exec, -1
    s_waitcnt vmcnt(16)
    v_mov_b32 v22, 2
    s_mov_b64 exec, 1
    ds_write_b32 v1, v22 offset:6784
    s_mov_b64 exec, -1
    s_waitcnt vmcnt(8)
    v_mov_b32 v22, 3
    s_mov_b64 exec, 1
    ds_write_b32 v1, v22 offset:6784
    s_mov_b64 exec, -1
    s_waitcnt vmcnt(0)
    v_mov_b32 v22, 4
    s_mov_b64 exec, 1
    ds_write_b32 v1, v22 offset:6784
    s_mov_b64 exec, -1
    s_mov_b32 s39, 0
W_84:
    ds_read_b32 v21, v1 offset:6820
    s_waitcnt lgkmcnt(0)
    v_readfirstlane_b32 s40, v21
    s_cmp_ge_u32 s40, 4
    s_cbranch_scc1 W_85
    s_add_u32 s39, s39, 1
    s_cmp_lt_u32 s39, 1048576
    s_cbranch_scc1 W_84
    s_branch L_end
W_85:
    s_mov_b32 m0, 0x12000
    s_nop 0
    global_load_lds_dwordx4 v16, s[12:13] offset:0 nt
    s_mov_b32 m0, 0x12400
    s_nop 0
    global_load_lds_dwordx4 v17, s[12:13] offset:0 nt
    s_mov_b32 m0, 0x12400
    s_nop 0
    global_load_lds_dwordx4 v16, s[12:13] offset:1024 nt
    s_mov_b32 m0, 0x12800
    s_nop 0
    global_load_lds_dwordx4 v17, s[12:13] offset:1024 nt
FAST_81:
    s_mov_b32 m0, 0x12f80
    s_nop 0
    global_load_lds_dwordx4 v16, s[12:13] offset:128 nt
    s_mov_b32 m0, 0x13380
    s_nop 0
    global_load_lds_dwordx4 v17, s[12:13] offset:128 nt
    s_mov_b32 m0, 0x13380
    s_nop 0
    global_load_lds_dwordx4 v16, s[12:13] offset:1152 nt
    s_mov_b32 m0, 0x13780
    s_nop 0
    global_load_lds_dwordx4 v17, s[12:13] offset:1152 nt
    s_mov_b32 m0, 0x13f00
    s_nop 0
    global_load_lds_dwordx4 v16, s[12:13] offset:256 nt
    s_mov_b32 m0, 0x14300
    s_nop 0
    global_load_lds_dwordx4 v17, s[12:13] offset:256 nt
    s_mov_b32 m0, 0x14300
    s_nop 0
    global_load_lds_dwordx4 v16, s[12:13] offset:1280 nt
    s_mov_b32 m0, 0x14700
    s_nop 0
    global_load_lds_dwordx4 v17, s[12:13] offset:1280 nt
    s_mov_b32 m0, 0x14e80
    s_nop 0
    global_load_lds_dwordx4 v16, s[12:13] offset:384 nt
    s_mov_b32 m0, 0x15280
    s_nop 0
    global_load_lds_dwordx4 v17, s[12:13] offset:384 nt
    s_mov_b32 m0, 0x15280
    s_nop 0
    global_load_lds_dwordx4 v16, s[12:13] offset:1408 nt
    s_mov_b32 m0, 0x15680
    s_nop 0
    global_load_lds_dwordx4 v17, s[12:13] offset:1408 nt
    s_waitcnt vmcnt(0)
    v_mov_b32 v22, 1
    s_mov_b64 exec, 1
    ds_write_b32 v1, v22 offset:6836
    s_mov_b64 exec, -1
    s_endpgm
LB_67:
    s_movk_i32 m0, 0x2000
    s_nop 0
    global_load_lds_dwordx4 v8, s[6:7] nt
    v_add_u32 v8, 0x8000, v8
    s_movk_i32 m0, 0x2400
    s_nop 0
    global_load_lds_dwordx4 v8, s[6:7] nt
    v_add_u32 v8, 0x38000, v8
    s_movk_i32 m0, 0x2800
    s_nop 0
    global_load_lds_dwordx4 v9, s[6:7] nt
    v_add_u32 v9, 0x8000, v9
    s_movk_i32 m0, 0x2c00
    s_nop 0
    global_load_lds_dwordx4 v9, s[6:7] nt
    v_add_u32 v9, 0x38000, v9
    s_movk_i32 m0, 0x3000
    s_nop 0
    global_load_lds_dwordx4 v10, s[6:7] nt
    v_add_u32 v10, 0x8000, v10
    s_movk_i32 m0, 0x3400
    s_nop 0
    global_load_lds_dwordx4 v10, s[6:7] nt
    v_add_u32 v10, 0x38000, v10
    s_movk_i32 m0, 0x3800
    s_nop 0
    global_load_lds_dwordx4 v11, s[6:7] nt
    v_add_u32 v11, 0x8000, v11
    s_movk_i32 m0, 0x3c00
    s_nop 0
    global_load_lds_dwordx4 v11, s[6:7] nt
    v_add_u32 v11, 0x38000, v11
    s_movk_i32 m0, 0x4000
    s_nop 0
    global_load_lds_dwordx4 v8, s[6:7] nt
    v_add_u32 v8, 0x8000, v8
    s_movk_i32 m0, 0x4400
    s_nop 0
    global_load_lds_dwordx4 v8, s[6:7] nt
    v_add_u32 v8, 0x38000, v8
    s_movk_i32 m0, 0x4800
    s_nop 0
    global_load_lds_dwordx4 v9, s[6:7] nt
    v_add_u32 v9, 0x8000, v9
    s_movk_i32 m0, 0x4c00
    s_nop 0
    global_load_lds_dwordx4 v9, s[6:7] nt
    v_add_u32 v9, 0x38000, v9
    s_movk_i32 m0, 0x5000
    s_nop 0
    global_load_lds_dwordx4 v10, s[6:7] nt
    v_add_u32 v10, 0x8000, v10
    s_movk_i32 m0, 0x5400
    s_nop 0
    global_load_lds_dwordx4 v10, s[6:7] nt
    v_add_u32 v10, 0x38000, v10
    s_movk_i32 m0, 0x5800
    s_nop 0
    global_load_lds_dwordx4 v11, s[6:7] nt
    v_add_u32 v11, 0x8000, v11
    s_movk_i32 m0, 0x5c00
    s_nop 0
    global_load_lds_dwordx4 v11, s[6:7] nt
    v_add_u32 v11, 0x38000, v11
    ds_read_b32 v21, v1 offset:6792
    s_waitcnt vmcnt(15)
    s_waitcnt lgkmcnt(0)
    v_readfirstlane_b32 s40, v21
    s_cmp_lg_u32 s40, 0
    s_cbranch_scc1 FAST_86
    s_movk_i32 m0, 0x6000
    s_nop 0
    global_load_lds_dwordx4 v8, s[6:7] nt
    v_add_u32 v8, 0x8000, v8
    s_waitcnt vmcnt(15)
    s_movk_i32 m0, 0x6400
    s_nop 0
    global_load_lds_dwordx4 v8, s[6:7] nt
    v_add_u32 v8, 0x38000, v8
    s_waitcnt vmcnt(15)
    s_movk_i32 m0, 0x6800
    s_nop 0
    global_load_lds_dwordx4 v9, s[6:7] nt
    v_add_u32 v9, 0x8000, v9
    s_waitcnt vmcnt(15)
    s_movk_i32 m0, 0x6c00
    s_nop 0
    global_load_lds_dwordx4 v9, s[6:7] nt
    v_add_u32 v9, 0x38000, v9
    ds_read_b32 v21, v1 offset:6792
    s_waitcnt vmcnt(15)
    s_waitcnt lgkmcnt(0)
    v_readfirstlane_b32 s40, v21
    s_cmp_lg_u32 s40, 0
    s_cbranch_scc1 FAST_87
    s_movk_i32 m0, 0x7000
    s_nop 0
    global_load_lds_dwordx4 v10, s[6:7] nt
    v_add_u32 v10, 0x8000, v10
    s_waitcnt vmcnt(15)
    s_movk_i32 m0, 0x7400
    s_nop 0
    global_load_lds_dwordx4 v10, s[6:7] nt
    v_add_u32 v10, 0x38000, v10
    s_waitcnt vmcnt(15)
    s_movk_i32 m0, 0x7800
    s_nop 0
    global_load_lds_dwordx4 v11, s[6:7] nt
    v_add_u32 v11, 0x8000, v11
    s_waitcnt vmcnt(15)
    s_movk_i32 m0, 0x7c00
    s_nop 0
    global_load_lds_dwordx4 v11, s[6:7] nt
    v_add_u32 v11, 0x38000, v11
    ds_read_b32 v21, v1 offset:6792
    s_waitcnt vmcnt(15)
    s_waitcnt lgkmcnt(0)
    v_readfirstlane_b32 s40, v21
    s_cmp_lg_u32 s40, 0
    s_cbranch_scc1 FAST_88
    s_mov_b32 m0, 0x8000
    s_nop 0
    global_load_lds_dwordx4 v8, s[6:7] nt
    v_add_u32 v8, 0x8000, v8
    s_waitcnt vmcnt(15)
    s_mov_b32 m0, 0x8400
    s_nop 0
    global_load_lds_dwordx4 v8, s[6:7] nt
    v_add_u32 v8, 0x38000, v8
    s_waitcnt vmcnt(15)
    s_mov_b32 m0, 0x8800
    s_nop 0
    global_load_lds_dwordx4 v9, s[6:7] nt
    v_add_u32 v9, 0x8000, v9
    s_waitcnt vmcnt(15)
    s_mov_b32 m0, 0x8c00
    s_nop 0
    global_load_lds_dwordx4 v9, s[6:7] nt
    v_add_u32 v9, 0x38000, v9
    ds_read_b32 v21, v1 offset:6792
    s_waitcnt vmcnt(15)
    s_waitcnt lgkmcnt(0)
    v_readfirstlane_b32 s40, v21
    s_cmp_lg_u32 s40, 0
    s_cbranch_scc1 FAST_89
    s_mov_b32 m0, 0x9000
    s_nop 0
    global_load_lds_dwordx4 v10, s[6:7] nt
    v_add_u32 v10, 0x8000, v10
    s_waitcnt vmcnt(15)
    s_mov_b32 m0, 0x9400
    s_nop 0
    global_load_lds_dwordx4 v10, s[6:7] nt
    v_add_u32 v10, 0x38000, v10
    s_waitcnt vmcnt(15)
    s_mov_b32 m0, 0x9800
    s_nop 0
    global_load_lds_dwordx4 v11, s[6:7] nt
    v_add_u32 v11, 0x8000, v11
    s_waitcnt vmcnt(15)
    s_mov_b32 m0, 0x9c00
    s_nop 0
    global_load_lds_dwordx4 v11, s[6:7] nt
    v_add_u32 v11, 0x38000, v11
    ds_read_b32 v21, v1 offset:6792
    s_waitcnt vmcnt(15)
    s_waitcnt lgkmcnt(0)
    v_readfirstlane_b32 s40, v21
    s_cmp_lg_u32 s40, 0
    s_cbranch_scc1 FAST_90
    s_mov_b32 m0, 0x16000
    s_nop 0
    global_load_lds_dwordx4 v18, s[18:19] offset:0 nt
    s_waitcnt vmcnt(15)
    s_mov_b32 m0, 0x16000
    s_nop 0
    global_load_lds_dwordx4 v18, s[18:19] offset:1024 nt
    s_waitcnt vmcnt(15)
    s_mov_b32 m0, 0x16000
    s_nop 0
    global_load_lds_dwordx4 v18, s[18:19] offset:2048 nt
    s_waitcnt vmcnt(15)
    s_mov_b32 m0, 0x16000
    s_nop 0
    global_load_lds_dwordx4 v18, s[18:19] offset:3072 nt
    ds_read_b32 v21, v1 offset:6792
    s_waitcnt vmcnt(15)
    s_waitcnt lgkmcnt(0)
    v_readfirstlane_b32 s40, v21
    s_cmp_lg_u32 s40, 0
    s_cbranch_scc1 FAST_91
    s_mov_b32 m0, 0x17000
    s_nop 0
    global_load_lds_dwordx4 v19, s[18:19] offset:0 nt
    s_waitcnt vmcnt(15)
    s_mov_b32 m0, 0x17000
    s_nop 0
    global_load_lds_dwordx4 v19, s[18:19] offset:1024 nt
    s_waitcnt vmcnt(15)
    s_mov_b32 m0, 0x17000
    s_nop 0
    global_load_lds_dwordx4 v19, s[18:19] offset:2048 nt
    s_waitcnt vmcnt(15)
    s_mov_b32 m0, 0x17000
    s_nop 0
    global_load_lds_dwordx4 v19, s[18:19] offset:3072 nt
    ds_read_b32 v21, v1 offset:6792
    s_waitcnt vmcnt(15)
    s_waitcnt lgkmcnt(0)
    v_readfirstlane_b32 s40, v21
    s_cmp_lg_u32 s40, 0
    s_cbranch_scc1 FAST_92
    s_mov_b32 m0, 0xa000
    s_nop 0
    global_load_lds_dwordx4 v12, s[8:9] nt
    v_add_u32 v12, 0x8000, v12
    s_waitcnt vmcnt(15)
    s_mov_b32 m0, 0xa400
    s_nop 0
    global_load_lds_dwordx4 v12, s[8:9] nt
    v_add_u32 v12, 0x18000, v12
    s_waitcnt vmcnt(15)
    s_mov_b32 m0, 0xa800
    s_nop 0
    global_load_lds_dwordx4 v13, s[8:9] nt
    v_add_u32 v13, 0x8000, v13
    s_waitcnt vmcnt(15)
    s_mov_b32 m0, 0xac00
    s_nop 0
    global_load_lds_dwordx4 v13, s[8:9] nt
    v_add_u32 v13, 0x18000, v13
    ds_read_b32 v21, v1 offset:6792
    s_waitcnt vmcnt(15)
    s_waitcnt lgkmcnt(0)
    v_readfirstlane_b32 s40, v21
    s_cmp_lg_u32 s40, 0
    s_cbranch_scc1 FAST_93
    s_mov_b32 m0, 0xb000
    s_nop 0
    global_load_lds_dwordx4 v12, s[8:9] nt
    v_add_u32 v12, 0x8000, v12
    s_waitcnt vmcnt(15)
    s_mov_b32 m0, 0xb400
    s_nop 0
    global_load_lds_dwordx4 v12, s[8:9] nt
    v_add_u32 v12, 0x18000, v12
    s_waitcnt vmcnt(15)
    s_mov_b32 m0, 0xb800
    s_nop 0
    global_load_lds_dwordx4 v13, s[8:9] nt
    v_add_u32 v13, 0x8000, v13
    s_waitcnt vmcnt(15)
    v_mov_b32 v22, 1
    s_mov_b64 exec, 1
    ds_write_b32 v1, v22 offset:6800
    s_mov_b64 exec, -1
    s_mov_b32 m0, 0xbc00
    s_nop 0
    global_load_lds_dwordx4 v13, s[8:9] nt
    v_add_u32 v13, 0x18000, v13
    ds_read_b32 v21, v1 offset:6792
    s_waitcnt vmcnt(15)
    s_waitcnt lgkmcnt(0)
    v_readfirstlane_b32 s40, v21
    s_cmp_lg_u32 s40, 0
    s_cbranch_scc1 FAST_94
    s_mov_b32 m0, 0xc000
    s_nop 0
    global_load_lds_dwordx4 v12, s[8:9] nt
    v_add_u32 v12, 0x8000, v12
    s_waitcnt vmcnt(15)
    s_mov_b32 m0, 0xc400
    s_nop 0
    global_load_lds_dwordx4 v12, s[8:9] nt
    v_add_u32 v12, 0x18000, v12
    s_waitcnt vmcnt(15)
    s_mov_b32 m0, 0xc800
    s_nop 0
    global_load_lds_dwordx4 v13, s[8:9] nt
    v_add_u32 v13, 0x8000, v13
    s_waitcnt vmcnt(15)
    s_mov_b32 m0, 0xcc00
    s_nop 0
    global_load_lds_dwordx4 v13, s[8:9] nt
    v_add_u32 v13, 0x18000, v13
    ds_read_b32 v21, v1 offset:6792
    s_waitcnt vmcnt(15)
    s_waitcnt lgkmcnt(0)
    v_readfirstlane_b32 s40, v21
    s_cmp_lg_u32 s40, 0
    s_cbranch_scc1 FAST_95
    s_mov_b32 m0, 0xd000
    s_nop 0
    global_load_lds_dwordx4 v12, s[8:9] nt
    v_add_u32 v12, 0x8000, v12
    s_waitcnt vmcnt(15)
    s_mov_b32 m0, 0xd400
    s_nop 0
    global_load_lds_dwordx4 v12, s[8:9] nt
    v_add_u32 v12, 0x18000, v12
    s_waitcnt vmcnt(15)
    s_mov_b32 m0, 0xd800
    s_nop 0
    global_load_lds_dwordx4 v13, s[8:9] nt
    v_add_u32 v13, 0x8000, v13
    s_waitcnt vmcnt(15)
    v_mov_b32 v22, 1
    s_mov_b64 exec, 1
    ds_write_b32 v1, v22 offset:6840
    s_mov_b64 exec, -1
    s_mov_b32 m0, 0xdc00
    s_nop 0
    global_load_lds_dwordx4 v13, s[8:9] nt
    v_add_u32 v13, 0x18000, v13
    ds_read_b32 v21, v1 offset:6792
    s_waitcnt vmcnt(15)
    s_waitcnt lgkmcnt(0)
    v_readfirstlane_b32 s40, v21
    s_cmp_lg_u32 s40, 0
    s_cbranch_scc1 FAST_96
    s_mov_b32 m0, 0xe000
    s_nop 0
    global_load_lds_dwordx4 v12, s[8:9] nt
    v_add_u32 v12, 0x8000, v12
    s_waitcnt vmcnt(15)
    s_mov_b32 m0, 0xe400
    s_nop 0
    global_load_lds_dwordx4 v12, s[8:9] nt
    v_add_u32 v12, 0x18000, v12
    s_waitcnt vmcnt(15)
    s_mov_b32 m0, 0xe800
    s_nop 0
    global_load_lds_dwordx4 v13, s[8:9] nt
    v_add_u32 v13, 0x8000, v13
    s_waitcnt vmcnt(15)
    s_mov_b32 m0, 0xec00
    s_nop 0
    global_load_lds_dwordx4 v13, s[8:9] nt
    v_add_u32 v13, 0x18000, v13
    ds_read_b32 v21, v1 offset:6792
    s_waitcnt vmcnt(15)
    s_waitcnt lgkmcnt(0)
    v_readfirstlane_b32 s40, v21
    s_cmp_lg_u32 s40, 0
    s_cbranch_scc1 FAST_97
    s_mov_b32 m0, 0xf000
    s_nop 0
    global_load_lds_dwordx4 v12, s[8:9] nt
    v_add_u32 v12, 0x8000, v12
    s_waitcnt vmcnt(15)
    s_mov_b32 m0, 0xf400
    s_nop 0
    global_load_lds_dwordx4 v12, s[8:9] nt
    v_add_u32 v12, 0x18000, v12
    s_waitcnt vmcnt(15)
    s_mov_b32 m0, 0xf800
    s_nop 0
    global_load_lds_dwordx4 v13, s[8:9] nt
    v_add_u32 v13, 0x8000, v13
    s_waitcnt vmcnt(15)
    v_mov_b32 v22, 1
    s_mov_b64 exec, 1
    ds_write_b32 v1, v22 offset:6784
    s_mov_b64 exec, -1
    s_mov_b32 m0, 0xfc00
    s_nop 0
    global_load_lds_dwordx4 v13, s[8:9] nt
    v_add_u32 v13, 0x18000, v13
    ds_read_b32 v21, v1 offset:6792
    s_waitcnt vmcnt(15)
    s_waitcnt lgkmcnt(0)
    v_readfirstlane_b32 s40, v21
    s_cmp_lg_u32 s40, 0
    s_cbranch_scc1 FAST_98
    s_mov_b32 m0, 0x10000
    s_nop 0
    global_load_lds_dwordx4 v12, s[8:9] nt
    v_add_u32 v12, 0x8000, v12
    s_waitcnt vmcnt(15)
    s_mov_b32 m0, 0x10400
    s_nop 0
    global_load_lds_dwordx4 v12, s[8:9] nt
    v_add_u32 v12, 0x18000, v12
    s_waitcnt vmcnt(15)
    s_mov_b32 m0, 0x10800
    s_nop 0
    global_load_lds_dwordx4 v13, s[8:9] nt
    v_add_u32 v13, 0x8000, v13
    s_waitcnt vmcnt(15)
    s_mov_b32 m0, 0x10c00
    s_nop 0
    global_load_lds_dwordx4 v13, s[8:9] nt
    v_add_u32 v13, 0x18000, v13
    ds_read_b32 v21, v1 offset:6792
    s_waitcnt vmcnt(15)
    s_waitcnt lgkmcnt(0)
    v_readfirstlane_b32 s40, v21
    s_cmp_lg_u32 s40, 0
    s_cbranch_scc1 FAST_99
    s_mov_b32 m0, 0x11000
    s_nop 0
    global_load_lds_dwordx4 v12, s[8:9] nt
    v_add_u32 v12, 0x8000, v12
    s_waitcnt vmcnt(15)
    s_mov_b32 m0, 0x11400
    s_nop 0
    global_load_lds_dwordx4 v12, s[8:9] nt
    v_add_u32 v12, 0x18000, v12
    s_waitcnt vmcnt(15)
    s_mov_b32 m0, 0x11800
    s_nop 0
    global_load_lds_dwordx4 v13, s[8:9] nt
    v_add_u32 v13, 0x8000, v13
    s_waitcnt vmcnt(15)
    v_mov_b32 v22, 2
    s_mov_b64 exec, 1
    ds_write_b32 v1, v22 offset:6784
    s_mov_b64 exec, -1
    s_mov_b32 m0, 0x11c00
    s_nop 0
    global_load_lds_dwordx4 v13, s[8:9] nt
    v_add_u32 v13, 0x18000, v13
    s_waitcnt vmcnt(8)
    v_mov_b32 v22, 3
    s_mov_b64 exec, 1
    ds_write_b32 v1, v22 offset:6784
    s_mov_b64 exec, -1
    s_waitcnt vmcnt(0)
    v_mov_b32 v22, 4
    s_mov_b64 exec, 1
    ds_write_b32 v1, v22 offset:6784
    s_mov_b64 exec, -1
    s_mov_b32 s39, 0
W_102:
    ds_read_b32 v21, v1 offset:6820
    s_waitcnt lgkmcnt(0)
    v_readfirstlane_b32 s40, v21
    s_cmp_ge_u32 s40, 4
    s_cbranch_scc1 W_103
    s_add_u32 s39, s39, 1
    s_cmp_lt_u32 s39, 1048576
    s_cbranch_scc1 W_102
    s_branch L_end
W_103:
    ds_read_b32 v21, v1 offset:6792
    s_waitcnt lgkmcnt(0)
    v_readfirstlane_b32 s40, v21
    s_cmp_lg_u32 s40, 0
    s_cbranch_scc1 FAST_100
    s_mov_b32 m0, 0x12000
    s_nop 0
    global_load_lds_dwordx4 v16, s[12:13] offset:0 nt
    s_mov_b32 m0, 0x12400
    s_nop 0
    global_load_lds_dwordx4 v17, s[12:13] offset:0 nt
    s_mov_b32 m0, 0x12400
    s_nop 0
    global_load_lds_dwordx4 v16, s[12:13] offset:1024 nt
    s_mov_b32 m0, 0x12800
    s_nop 0
    global_load_lds_dwordx4 v17, s[12:13] offset:1024 nt
    ds_read_b32 v21, v1 offset:6792
    s_waitcnt lgkmcnt(0)
    v_readfirstlane_b32 s40, v21
    s_cmp_lg_u32 s40, 0
    s_cbranch_scc1 FAST_101
    s_mov_b32 m0, 0x12f80
    s_nop 0
    global_load_lds_dwordx4 v16, s[12:13] offset:128 nt
    s_mov_b32 m0, 0x13380
    s_nop 0
    global_load_lds_dwordx4 v17, s[12:13] offset:128 nt
    s_mov_b32 m0, 0x13380
    s_nop 0
    global_load_lds_dwordx4 v16, s[12:13] offset:1152 nt
    s_mov_b32 m0, 0x13780
    s_nop 0
    global_load_lds_dwordx4 v17, s[12:13] offset:1152 nt
    s_mov_b32 m0, 0x13f00
    s_nop 0
    global_load_lds_dwordx4 v16, s[12:13] offset:256 nt
    s_mov_b32 m0, 0x14300
    s_nop 0
    global_load_lds_dwordx4 v17, s[12:13] offset:256 nt
    s_mov_b32 m0, 0x14300
    s_nop 0
    global_load_lds_dwordx4 v16, s[12:13] offset:1280 nt
    s_mov_b32 m0, 0x14700
    s_nop 0
    global_load_lds_dwordx4 v17, s[12:13] offset:1280 nt
    s_mov_b32 m0, 0x14e80
    s_nop 0
    global_load_lds_dwordx4 v16, s[12:13] offset:384 nt
    s_mov_b32 m0, 0x15280
    s_nop 0
    global_load_lds_dwordx4 v17, s[12:13] offset:384 nt
    s_mov_b32 m0, 0x15280
    s_nop 0
    global_load_lds_dwordx4 v16, s[12:13] offset:1408 nt
    s_mov_b32 m0, 0x15680
    s_nop 0
    global_load_lds_dwordx4 v17, s[12:13] offset:1408 nt
    s_waitcnt vmcnt(0)
    v_mov_b32 v22, 1
    s_mov_b64 exec, 1
    ds_write_b32 v1, v22 offset:6836
    s_mov_b64 exec, -1
    s_endpgm
FAST_86:
    s_movk_i32 m0, 0x6000
    s_nop 0
    global_load_lds_dwordx4 v8, s[6:7] nt
    v_add_u32 v8, 0x8000, v8
    s_movk_i32 m0, 0x6400
    s_nop 0
    global_load_lds_dwordx4 v8, s[6:7] nt
    v_add_u32 v8, 0x38000, v8
    s_movk_i32 m0, 0x6800
    s_nop 0
    global_load_lds_dwordx4 v9, s[6:7] nt
    v_add_u32 v9, 0x8000, v9
    s_movk_i32 m0, 0x6c00
    s_nop 0
    global_load_lds_dwordx4 v9, s[6:7] nt
    v_add_u32 v9, 0x38000, v9
FAST_87:
    s_movk_i32 m0, 0x7000
    s_nop 0
    global_load_lds_dwordx4 v10, s[6:7] nt
    v_add_u32 v10, 0x8000, v10
    s_movk_i32 m0, 0x7400
    s_nop 0
    global_load_lds_dwordx4 v10, s[6:7] nt
    v_add_u32 v10, 0x38000, v10
    s_movk_i32 m0, 0x7800
    s_nop 0
    global_load_lds_dwordx4 v11, s[6:7] nt
    v_add_u32 v11, 0x8000, v11
    s_movk_i32 m0, 0x7c00
    s_nop 0
    global_load_lds_dwordx4 v11, s[6:7] nt
    v_add_u32 v11, 0x38000, v11
FAST_88:
    s_mov_b32 m0, 0x8000
    s_nop 0
    global_load_lds_dwordx4 v8, s[6:7] nt
    v_add_u32 v8, 0x8000, v8
    s_mov_b32 m0, 0x8400
    s_nop 0
    global_load_lds_dwordx4 v8, s[6:7] nt
    v_add_u32 v8, 0x38000, v8
    s_mov_b32 m0, 0x8800
    s_nop 0
    global_load_lds_dwordx4 v9, s[6:7] nt
    v_add_u32 v9, 0x8000, v9
    s_mov_b32 m0, 0x8c00
    s_nop 0
    global_load_lds_dwordx4 v9, s[6:7] nt
    v_add_u32 v9, 0x38000, v9
FAST_89:
    s_mov_b32 m0, 0x9000
    s_nop 0
    global_load_lds_dwordx4 v10, s[6:7] nt
    v_add_u32 v10, 0x8000, v10
    s_mov_b32 m0, 0x9400
    s_nop 0
    global_load_lds_dwordx4 v10, s[6:7] nt
    v_add_u32 v10, 0x38000, v10
    s_mov_b32 m0, 0x9800
    s_nop 0
    global_load_lds_dwordx4 v11, s[6:7] nt
    v_add_u32 v11, 0x8000, v11
    s_mov_b32 m0, 0x9c00
    s_nop 0
    global_load_lds_dwordx4 v11, s[6:7] nt
    v_add_u32 v11, 0x38000, v11
FAST_90:
    s_mov_b32 m0, 0x16000
    s_nop 0
    global_load_lds_dwordx4 v18, s[18:19] offset:0 nt
    s_mov_b32 m0, 0x16000
    s_nop 0
    global_load_lds_dwordx4 v18, s[18:19] offset:1024 nt
    s_mov_b32 m0, 0x16000
    s_nop 0
    global_load_lds_dwordx4 v18, s[18:19] offset:2048 nt
    s_mov_b32 m0, 0x16000
    s_nop 0
    global_load_lds_dwordx4 v18, s[18:19] offset:3072 nt
FAST_91:
    s_mov_b32 m0, 0x17000
    s_nop 0
    global_load_lds_dwordx4 v19, s[18:19] offset:0 nt
    s_mov_b32 m0, 0x17000
    s_nop 0
    global_load_lds_dwordx4 v19, s[18:19] offset:1024 nt
    s_mov_b32 m0, 0x17000
    s_nop 0
    global_load_lds_dwordx4 v19, s[18:19] offset:2048 nt
    s_mov_b32 m0, 0x17000
    s_nop 0
    global_load_lds_dwordx4 v19, s[18:19] offset:3072 nt
FAST_92:
    s_waitcnt vmcnt(39)
    s_mov_b32 m0, 0xa000
    s_nop 0
    global_load_lds_dwordx4 v12, s[8:9] nt
    v_add_u32 v12, 0x8000, v12
    s_waitcnt vmcnt(39)
    s_mov_b32 m0, 0xa400
    s_nop 0
    global_load_lds_dwordx4 v12, s[8:9] nt
    v_add_u32 v12, 0x18000, v12
    s_waitcnt vmcnt(39)
    s_mov_b32 m0, 0xa800
    s_nop 0
    global_load_lds_dwordx4 v13, s[8:9] nt
    v_add_u32 v13, 0x8000, v13
    s_waitcnt vmcnt(39)
    s_mov_b32 m0, 0xac00
    s_nop 0
    global_load_lds_dwordx4 v13, s[8:9] nt
    v_add_u32 v13, 0x18000, v13
FAST_93:
    s_waitcnt vmcnt(39)
    s_mov_b32 m0, 0xb000
    s_nop 0
    global_load_lds_dwordx4 v12, s[8:9] nt
    v_add_u32 v12, 0x8000, v12
    s_waitcnt vmcnt(39)
    s_mov_b32 m0, 0xb400
    s_nop 0
    global_load_lds_dwordx4 v12, s[8:9] nt
    v_add_u32 v12, 0x18000, v12
    s_waitcnt vmcnt(39)
    s_mov_b32 m0, 0xb800
    s_nop 0
    global_load_lds_dwordx4 v13, s[8:9] nt
    v_add_u32 v13, 0x8000, v13
    s_waitcnt vmcnt(39)
    s_mov_b32 m0, 0xbc00
    s_nop 0
    global_load_lds_dwordx4 v13, s[8:9] nt
    v_add_u32 v13, 0x18000, v13
FAST_94:
    s_waitcnt vmcnt(39)
    s_mov_b32 m0, 0xc000
    s_nop 0
    global_load_lds_dwordx4 v12, s[8:9] nt
    v_add_u32 v12, 0x8000, v12
    s_waitcnt vmcnt(39)
    s_mov_b32 m0, 0xc400
    s_nop 0
    global_load_lds_dwordx4 v12, s[8:9] nt
    v_add_u32 v12, 0x18000, v12
    s_waitcnt vmcnt(39)
    s_mov_b32 m0, 0xc800
    s_nop 0
    global_load_lds_dwordx4 v13, s[8:9] nt
    v_add_u32 v13, 0x8000, v13
    s_waitcnt vmcnt(39)
    s_mov_b32 m0, 0xcc00
    s_nop 0
    global_load_lds_dwordx4 v13, s[8:9] nt
    v_add_u32 v13, 0x18000, v13
FAST_95:
    s_waitcnt vmcnt(39)
    s_mov_b32 m0, 0xd000
    s_nop 0
    global_load_lds_dwordx4 v12, s[8:9] nt
    v_add_u32 v12, 0x8000, v12
    s_waitcnt vmcnt(39)
    s_mov_b32 m0, 0xd400
    s_nop 0
    global_load_lds_dwordx4 v12, s[8:9] nt
    v_add_u32 v12, 0x18000, v12
    s_waitcnt vmcnt(39)
    s_mov_b32 m0, 0xd800
    s_nop 0
    global_load_lds_dwordx4 v13, s[8:9] nt
    v_add_u32 v13, 0x8000, v13
    s_waitcnt vmcnt(39)
    s_mov_b32 m0, 0xdc00
    s_nop 0
    global_load_lds_dwordx4 v13, s[8:9] nt
    v_add_u32 v13, 0x18000, v13
FAST_96:
    s_waitcnt vmcnt(39)
    s_mov_b32 m0, 0xe000
    s_nop 0
    global_load_lds_dwordx4 v12, s[8:9] nt
    v_add_u32 v12, 0x8000, v12
    s_waitcnt vmcnt(39)
    s_mov_b32 m0, 0xe400
    s_nop 0
    global_load_lds_dwordx4 v12, s[8:9] nt
    v_add_u32 v12, 0x18000, v12
    s_waitcnt vmcnt(39)
    s_mov_b32 m0, 0xe800
    s_nop 0
    global_load_lds_dwordx4 v13, s[8:9] nt
    v_add_u32 v13, 0x8000, v13
    s_waitcnt vmcnt(39)
    s_mov_b32 m0, 0xec00
    s_nop 0
    global_load_lds_dwordx4 v13, s[8:9] nt
    v_add_u32 v13, 0x18000, v13
FAST_97:
    s_waitcnt vmcnt(39)
    s_mov_b32 m0, 0xf000
    s_nop 0
    global_load_lds_dwordx4 v12, s[8:9] nt
    v_add_u32 v12, 0x8000, v12
    s_waitcnt vmcnt(39)
    s_mov_b32 m0, 0xf400
    s_nop 0
    global_load_lds_dwordx4 v12, s[8:9] nt
    v_add_u32 v12, 0x18000, v12
    s_waitcnt vmcnt(39)
    s_mov_b32 m0, 0xf800
    s_nop 0
    global_load_lds_dwordx4 v13, s[8:9] nt
    v_add_u32 v13, 0x8000, v13
    s_waitcnt vmcnt(39)
    s_mov_b32 m0, 0xfc00
    s_nop 0
    global_load_lds_dwordx4 v13, s[8:9] nt
    v_add_u32 v13, 0x18000, v13
FAST_98:
    s_waitcnt vmcnt(39)
    s_mov_b32 m0, 0x10000
    s_nop 0
    global_load_lds_dwordx4 v12, s[8:9] nt
    v_add_u32 v12, 0x8000, v12
    s_waitcnt vmcnt(39)
    s_mov_b32 m0, 0x10400
    s_nop 0
    global_load_lds_dwordx4 v12, s[8:9] nt
    v_add_u32 v12, 0x18000, v12
    s_waitcnt vmcnt(39)
    s_mov_b32 m0, 0x10800
    s_nop 0
    global_load_lds_dwordx4 v13, s[8:9] nt
    v_add_u32 v13, 0x8000, v13
    s_waitcnt vmcnt(39)
    s_mov_b32 m0, 0x10c00
    s_nop 0
    global_load_lds_dwordx4 v13, s[8:9] nt
    v_add_u32 v13, 0x18000, v13
FAST_99:
    s_waitcnt vmcnt(39)
    s_mov_b32 m0, 0x11000
    s_nop 0
    global_load_lds_dwordx4 v12, s[8:9] nt
    v_add_u32 v12, 0x8000, v12
    s_waitcnt vmcnt(39)
    s_mov_b32 m0, 0x11400
    s_nop 0
    global_load_lds_dwordx4 v12, s[8:9] nt
    v_add_u32 v12, 0x18000, v12
    s_waitcnt vmcnt(39)
    s_mov_b32 m0, 0x11800
    s_nop 0
    global_load_lds_dwordx4 v13, s[8:9] nt
    v_add_u32 v13, 0x8000, v13
    s_waitcnt vmcnt(39)
    v_mov_b32 v22, 1
    s_mov_b64 exec, 1
    ds_write_b32 v1, v22 offset:6800
    s_mov_b64 exec, -1
    s_mov_b32 m0, 0x11c00
    s_nop 0
    global_load_lds_dwordx4 v13, s[8:9] nt
    v_add_u32 v13, 0x18000, v13
FAST_100:
    s_waitcnt vmcnt(32)
    v_mov_b32 v22, 1
    s_mov_b64 exec, 1
    ds_write_b32 v1, v22 offset:6840
    s_mov_b64 exec, -1
    s_waitcnt vmcnt(24)
    v_mov_b32 v22, 1
    s_mov_b64 exec, 1
    ds_write_b32 v1, v22 offset:6784
    s_mov_b64 exec, -1
    s_waitcnt vmcnt(16)
    v_mov_b32 v22, 2
    s_mov_b64 exec, 1
    ds_write_b32 v1, v22 offset:6784
    s_mov_b64 exec, -1
    s_waitcnt vmcnt(8)
    v_mov_b32 v22, 3
    s_mov_b64 exec, 1
    ds_write_b32 v1, v22 offset:6784
    s_mov_b64 exec, -1
    s_waitcnt vmcnt(0)
    v_mov_b32 v22, 4
    s_mov_b64 exec, 1
    ds_write_b32 v1, v22 offset:6784
    s_mov_b64 exec, -1
    s_mov_b32 s39, 0
W_104:
    ds_read_b32 v21, v1 offset:6820
    s_waitcnt lgkmcnt(0)
    v_readfirstlane_b32 s40, v21
    s_cmp_ge_u32 s40, 4
    s_cbranch_scc1 W_105
    s_add_u32 s39, s39, 1
    s_cmp_lt_u32 s39, 1048576
    s_cbranch_scc1 W_104
    s_branch L_end
W_105:
    s_mov_b32 m0, 0x12000
    s_nop 0
    global_load_lds_dwordx4 v16, s[12:13] offset:0 nt
    s_mov_b32 m0, 0x12400
    s_nop 0
    global_load_lds_dwordx4 v17, s[12:13] offset:0 nt
    s_mov_b32 m0, 0x12400
    s_nop 0
    global_load_lds_dwordx4 v16, s[12:13] offset:1024 nt
    s_mov_b32 m0, 0x12800
    s_nop 0
    global_load_lds_dwordx4 v17, s[12:13] offset:1024 nt
FAST_101:
    s_mov_b32 m0, 0x12f80
    s_nop 0
    global_load_lds_dwordx4 v16, s[12:13] offset:128 nt
    s_mov_b32 m0, 0x13380
    s_nop 0
    global_load_lds_dwordx4 v17, s[12:13] offset:128 nt
    s_mov_b32 m0, 0x13380
    s_nop 0
    global_load_lds_dwordx4 v16, s[12:13] offset:1152 nt
    s_mov_b32 m0, 0x13780
    s_nop 0
    global_load_lds_dwordx4 v17, s[12:13] offset:1152 nt
    s_mov_b32 m0, 0x13f00
    s_nop 0
    global_load_lds_dwordx4 v16, s[12:13] offset:256 nt
    s_mov_b32 m0, 0x14300
    s_nop 0
    global_load_lds_dwordx4 v17, s[12:13] offset:256 nt
    s_mov_b32 m0, 0x14300
    s_nop 0
    global_load_lds_dwordx4 v16, s[12:13] offset:1280 nt
    s_mov_b32 m0, 0x14700
    s_nop 0
    global_load_lds_dwordx4 v17, s[12:13] offset:1280 nt
    s_mov_b32 m0, 0x14e80
    s_nop 0
    global_load_lds_dwordx4 v16, s[12:13] offset:384 nt
    s_mov_b32 m0, 0x15280
    s_nop 0
    global_load_lds_dwordx4 v17, s[12:13] offset:384 nt
    s_mov_b32 m0, 0x15280
    s_nop 0
    global_load_lds_dwordx4 v16, s[12:13] offset:1408 nt
    s_mov_b32 m0, 0x15680
    s_nop 0
    global_load_lds_dwordx4 v17, s[12:13] offset:1408 nt
    s_waitcnt vmcnt(0)
    v_mov_b32 v22, 1
    s_mov_b64 exec, 1
    ds_write_b32 v1, v22 offset:6836
    s_mov_b64 exec, -1
    s_endpgm
L_end:
    s_endpgm
L_code_end:
.section .rodata,"a"
.p2align 6
.amdhsa_kernel recurrent_scan__sliding_block_cached__dense_activation_relu__decode_kernel
  .amdhsa_next_free_vgpr 192
  .amdhsa_next_free_sgpr 96
  .amdhsa_accum_offset 192
  .amdhsa_group_segment_fixed_size 0
  .amdhsa_kernarg_size 88
  .amdhsa_user_sgpr_count 2
  .amdhsa_user_sgpr_kernarg_segment_ptr 1
  .amdhsa_system_sgpr_workgroup_id_x 1
  .amdhsa_float_denorm_mode_32 3
.end_amdhsa_kernel
```
